```python
import torch

def _softmax(x, axis=-1):
    return torch.softmax(x, dim=axis)
def _gelu(x):
    return torch.nn.functional.gelu(x, approximate="tanh")
def _silu(x):
    return torch.nn.functional.silu(x)
def _sigmoid(x):
    return torch.sigmoid(x)
def _layernorm(x, axis=-1, eps=1e-5):
    m = x.mean(dim=axis, keepdim=True)
    v = x.var(dim=axis, keepdim=True, unbiased=False)
    return (x - m) / torch.sqrt(v + eps)
def _scatter_add(tgt, idx, src, axis=0):
    return tgt.clone().index_add_(axis, idx, src)
def _segment_sum(src, seg, n):
    out = torch.zeros((n,) + src.shape[1:], dtype=src.dtype)
    return out.index_add_(0, seg, src)
def _pad(x, pw):
    flat = tuple(v for pair in reversed(pw) for v in pair)
    return torch.nn.functional.pad(x, flat)

kernel_name = 'sequential_preLN__sliding_local_dilated__mixer_channel_mlp__prompt'

def setup_inputs():

    _w = (lambda a: (lambda t: t.to(torch.bfloat16) if t.is_floating_point() else t)(torch.as_tensor(a)))
    def _A_setup():
        B, S, D = 1, 2048, 512
        return {
            "x": _w((lambda *s: torch.randn(*s, dtype=torch.bfloat16) * 0.05)(B, S, D)),
            "wqkv": _w((lambda *s: torch.randn(*s, dtype=torch.bfloat16) * 0.05)(D, 3 * D)),
            "wo": _w((lambda *s: torch.randn(*s, dtype=torch.bfloat16) * 0.05)(D, D)),
        }
    _A_in = _A_setup()

    def _B_setup():
        B, S, D, F = 1, 2048, 512, 1792
        return {
            "x": _w((lambda *s: torch.randn(*s, dtype=torch.bfloat16) * 0.05)(B, S, D)),
            "w1": _w((lambda *s: torch.randn(*s, dtype=torch.bfloat16) * 3.2)(D, F) * (D ** -0.5)),
            "b1": _w((lambda *s: torch.randn(*s, dtype=torch.bfloat16) * 1.6)(F)),
            "w2": _w((lambda *s: torch.randn(*s, dtype=torch.bfloat16) * 0.2)(F, D) * (F ** -0.5)),
            "b2": _w((lambda *s: torch.randn(*s, dtype=torch.bfloat16) * 0.2)(D)),
        }
    _B_in = _B_setup()

    return {
        "A_x": _A_in["x"],
        "A_wqkv": _A_in["wqkv"],
        "A_wo": _A_in["wo"],
        "B_x": _B_in["x"],
        "B_w1": _B_in["w1"],
        "B_b1": _B_in["b1"],
        "B_w2": _B_in["w2"],
        "B_b2": _B_in["b2"],
    }

def reference(A_x, A_wqkv, A_wo, B_x, B_w1, B_b1, B_w2, B_b2):
    def _A_ref(x, wqkv, wo):
        B, S, D = x.shape
        H = 32; Dh = D // H
        W, dil = 8, 2
        qkv = (lambda x, *d: x.permute(*d))((x @ wqkv).reshape(B, S, 3, H, Dh), 2, 0, 3, 1, 4)
        q, k, v = qkv[0], qkv[1], qkv[2]
        scale = Dh ** -0.5
        pos = torch.arange(S)
        off = torch.arange(W) * dil
        idx = pos[:, None] - off[None, :]
        mask = idx >= 0
        idx_c = torch.where(mask, idx, 0).reshape(-1)
        kg = k[:, :, idx_c, :].reshape(B, H, S, W, Dh)
        vg = v[:, :, idx_c, :].reshape(B, H, S, W, Dh)
        logits = torch.einsum("bhsd,bhswd->bhsw", q, kg) * scale
        logits = torch.where(mask[None, None, :, :], logits, -1e9)
        attn = _softmax(logits, axis=-1)
        o = torch.einsum("bhsw,bhswd->bhsd", attn, vg)
        return (lambda x, *d: x.permute(*d))(o, 0, 2, 1, 3).reshape(B, S, D) @ wo

    def _B_ref(x, w1, b1, w2, b2):
        y = _layernorm(x, axis=-1)
        h = _gelu(torch.einsum("bsd,df->bsf", y, w1) + b1)
        return torch.einsum("bsf,fd->bsd", h, w2) + b2

    x = A_x
    h = x + _A_ref(_layernorm(x, axis=-1), A_wqkv, A_wo)
    h2 = h + _B_ref(_layernorm(h, axis=-1), B_w1, B_b1, B_w2, B_b2)
    return h2
```

```asm
; @launch kernel=k1_qkv_attn_kernel grid=(256,1,1) block=(512,1,1) lds=131584
; @launch kernel=k2_wo_kernel grid=(256,1,1) block=(512,1,1) lds=131072
; @launch kernel=k3_w1_kernel grid=(256,1,1) block=(512,1,1) lds=131584
; @launch kernel=k4_w2_kernel grid=(256,1,1) block=(512,1,1) lds=98304
.amdgcn_target "amdgcn-amd-amdhsa--gfx950"
.text
.globl k1_qkv_attn_kernel
.p2align 8
.type k1_qkv_attn_kernel,@function
k1_qkv_attn_kernel:
    s_cmp_ge_u32 s2, 256
    s_cbranch_scc1 L_k1_done
    s_load_dwordx16 s[64:79], s[0:1], 0
    s_load_dwordx4 s[80:83], s[0:1], 64
    s_load_dwordx2 s[84:85], s[0:1], 80
    v_and_b32 v1, 63, v0
    v_lshrrev_b32 v4, 6, v0
    v_and_b32 v2, 15, v0
    v_bfe_u32 v3, v0, 4, 2
    v_readfirstlane_b32 s26, v4
    s_waitcnt lgkmcnt(0)
    s_lshr_b32 s51, s26, 2
    s_and_b32 s26, s26, 3
    s_bfe_u32 s24, s2, 0x20001
    s_lshl_b32 s24, s24, 2
    s_lshr_b32 s25, s2, 6
    s_add_u32 s24, s24, s25
    s_and_b32 s25, s2, 1
    s_lshl_b32 s25, s25, 3
    s_bfe_u32 s3, s2, 0x30003
    s_add_u32 s25, s25, s3
    s_mov_b32 s12, s64
    s_and_b32 s13, s65, 0xffff
    s_mov_b32 s14, 2097152
    s_mov_b32 s15, 0x00020000
    s_mov_b32 s16, s66
    s_and_b32 s17, s67, 0xffff
    s_mov_b32 s18, 1572864
    s_mov_b32 s19, 0x00020000
    s_mov_b32 s20, s84
    s_and_b32 s21, s85, 0xffff
    s_mov_b32 s22, 2097152
    s_mov_b32 s23, 0x00020000
    s_lshl_b32 s27, s24, 7
    s_sub_u32 s28, s27, 16
    s_lshl_b32 s30, s25, 6
    v_lshrrev_b32 v5, 3, v1
    v_and_b32 v6, 7, v1
    s_lshl_b32 s3, s26, 2
    v_lshrrev_b32 v7, 1, v5
    v_add_u32 v7, s3, v7
    v_and_b32 v7, 7, v7
    v_xor_b32 v6, v6, v7
    s_mul_i32 s3, s26, 8
    s_add_u32 s3, s3, s28
    v_add_u32 v5, s3, v5
    s_mov_b32 s3, 1024
    v_mul_lo_u32 v5, v5, s3
    v_lshl_add_u32 v8, v6, 4, v5
    s_lshl_b32 s3, s26, 6
    s_add_u32 s3, s3, 0
    v_add_u32 v12, s3, v1
    v_mul_u32_u24 v13, 2731, v12
    v_lshrrev_b32 v13, 15, v13
    v_mul_u32_u24 v14, 12, v13
    v_sub_u32 v14, v12, v14
    v_lshrrev_b32 v15, 1, v14
    v_and_b32 v14, 1, v14
    v_bfe_u32 v16, v13, 3, 1
    v_sub_u32 v15, v15, v16
    v_add_u32 v15, 6, v15
    v_subrev_u32 v16, 6, v15
    v_min_u32 v15, v15, v16
    v_lshrrev_b32 v16, 1, v15
    v_and_b32 v15, 1, v15
    v_lshlrev_b32 v15, 5, v15
    v_lshl_add_u32 v15, v14, 4, v15
    v_lshl_add_u32 v15, v16, 10, v15
    v_mul_u32_u24 v13, 3072, v13
    v_add3_u32 v9, v13, v15, s30
    s_lshl_b32 s3, s26, 6
    s_add_u32 s3, s3, 256
    v_add_u32 v12, s3, v1
    v_mul_u32_u24 v13, 2731, v12
    v_lshrrev_b32 v13, 15, v13
    v_mul_u32_u24 v14, 12, v13
    v_sub_u32 v14, v12, v14
    v_lshrrev_b32 v15, 1, v14
    v_and_b32 v14, 1, v14
    v_bfe_u32 v16, v13, 3, 1
    v_sub_u32 v15, v15, v16
    v_add_u32 v15, 6, v15
    v_subrev_u32 v16, 6, v15
    v_min_u32 v15, v15, v16
    v_lshrrev_b32 v16, 1, v15
    v_and_b32 v15, 1, v15
    v_lshlrev_b32 v15, 5, v15
    v_lshl_add_u32 v15, v14, 4, v15
    v_lshl_add_u32 v15, v16, 10, v15
    v_mul_u32_u24 v13, 3072, v13
    v_add3_u32 v10, v13, v15, s30
    s_lshl_b32 s3, s26, 6
    s_add_u32 s3, s3, 512
    v_add_u32 v12, s3, v1
    v_mul_u32_u24 v13, 2731, v12
    v_lshrrev_b32 v13, 15, v13
    v_mul_u32_u24 v14, 12, v13
    v_sub_u32 v14, v12, v14
    v_lshrrev_b32 v15, 1, v14
    v_and_b32 v14, 1, v14
    v_bfe_u32 v16, v13, 3, 1
    v_sub_u32 v15, v15, v16
    v_add_u32 v15, 6, v15
    v_subrev_u32 v16, 6, v15
    v_min_u32 v15, v15, v16
    v_lshrrev_b32 v16, 1, v15
    v_and_b32 v15, 1, v15
    v_lshlrev_b32 v15, 5, v15
    v_lshl_add_u32 v15, v14, 4, v15
    v_lshl_add_u32 v15, v16, 10, v15
    v_mul_u32_u24 v13, 3072, v13
    v_add3_u32 v11, v13, v15, s30
    v_add_u32 v204, 32768, v8
    v_add_u32 v205, 65536, v8
    v_add_u32 v206, 98304, v8
    v_add_u32 v207, 131072, v8
    s_mov_b32 s40, 0
    s_mov_b32 s41, 0
    s_add_u32 s42, s24, s25
    s_and_b32 s42, s42, 7
    s_mul_i32 s43, s42, 196608
    s_mul_i32 s42, s42, 128
    s_mov_b32 s44, 0
    s_lshl_b32 s46, s26, 10
    s_cmp_eq_u32 s51, 0
    s_cbranch_scc1 L_k1_compute
L_k1_loader:
    s_add_u32 s47, s41, s46
    s_add_u32 m0, s47, 0
    s_nop 0
    buffer_load_dwordx4 v8, s[12:15], s42 offen lds
    s_add_u32 m0, s47, 4096
    s_nop 0
    buffer_load_dwordx4 v204, s[12:15], s42 offen lds
    s_add_u32 m0, s47, 8192
    s_nop 0
    buffer_load_dwordx4 v205, s[12:15], s42 offen lds
    s_add_u32 m0, s47, 12288
    s_nop 0
    buffer_load_dwordx4 v206, s[12:15], s42 offen lds
    s_add_u32 m0, s47, 16384
    s_nop 0
    buffer_load_dwordx4 v207, s[12:15], s42 offen lds
    s_add_u32 m0, s47, 20480
    s_add_u32 s48, s43, 0
    buffer_load_dwordx4 v9, s[16:19], s48 offen lds
    s_add_u32 m0, s47, 24576
    s_add_u32 s48, s43, 0
    buffer_load_dwordx4 v10, s[16:19], s48 offen lds
    s_add_u32 m0, s47, 28672
    s_add_u32 s48, s43, 0
    buffer_load_dwordx4 v11, s[16:19], s48 offen lds
    s_add_u32 s41, s41, 32768
    s_cmp_ge_u32 s41, 98304
    s_cselect_b32 s41, 0, s41
    s_add_u32 s42, s42, 128
    s_add_u32 s43, s43, 196608
    s_cmp_ge_u32 s42, 1024
    s_cselect_b32 s42, 0, s42
    s_cselect_b32 s43, 0, s43
    s_add_u32 s47, s41, s46
    s_add_u32 m0, s47, 0
    s_nop 0
    buffer_load_dwordx4 v8, s[12:15], s42 offen lds
    s_add_u32 m0, s47, 4096
    s_nop 0
    buffer_load_dwordx4 v204, s[12:15], s42 offen lds
    s_add_u32 m0, s47, 8192
    s_nop 0
    buffer_load_dwordx4 v205, s[12:15], s42 offen lds
    s_add_u32 m0, s47, 12288
    s_nop 0
    buffer_load_dwordx4 v206, s[12:15], s42 offen lds
    s_add_u32 m0, s47, 16384
    s_nop 0
    buffer_load_dwordx4 v207, s[12:15], s42 offen lds
    s_add_u32 m0, s47, 20480
    s_add_u32 s48, s43, 0
    buffer_load_dwordx4 v9, s[16:19], s48 offen lds
    s_add_u32 m0, s47, 24576
    s_add_u32 s48, s43, 0
    buffer_load_dwordx4 v10, s[16:19], s48 offen lds
    s_add_u32 m0, s47, 28672
    s_add_u32 s48, s43, 0
    buffer_load_dwordx4 v11, s[16:19], s48 offen lds
    s_add_u32 s41, s41, 32768
    s_cmp_ge_u32 s41, 98304
    s_cselect_b32 s41, 0, s41
    s_add_u32 s42, s42, 128
    s_add_u32 s43, s43, 196608
    s_cmp_ge_u32 s42, 1024
    s_cselect_b32 s42, 0, s42
    s_cselect_b32 s43, 0, s43
    s_waitcnt vmcnt(8)
    s_barrier
    s_add_u32 s47, s41, s46
    s_add_u32 m0, s47, 0
    s_nop 0
    buffer_load_dwordx4 v8, s[12:15], s42 offen lds
    s_add_u32 m0, s47, 4096
    s_nop 0
    buffer_load_dwordx4 v204, s[12:15], s42 offen lds
    s_add_u32 m0, s47, 8192
    s_nop 0
    buffer_load_dwordx4 v205, s[12:15], s42 offen lds
    s_add_u32 m0, s47, 12288
    s_nop 0
    buffer_load_dwordx4 v206, s[12:15], s42 offen lds
    s_add_u32 m0, s47, 16384
    s_nop 0
    buffer_load_dwordx4 v207, s[12:15], s42 offen lds
    s_add_u32 m0, s47, 20480
    s_add_u32 s48, s43, 0
    buffer_load_dwordx4 v9, s[16:19], s48 offen lds
    s_add_u32 m0, s47, 24576
    s_add_u32 s48, s43, 0
    buffer_load_dwordx4 v10, s[16:19], s48 offen lds
    s_add_u32 m0, s47, 28672
    s_add_u32 s48, s43, 0
    buffer_load_dwordx4 v11, s[16:19], s48 offen lds
    s_add_u32 s41, s41, 32768
    s_cmp_ge_u32 s41, 98304
    s_cselect_b32 s41, 0, s41
    s_add_u32 s42, s42, 128
    s_add_u32 s43, s43, 196608
    s_cmp_ge_u32 s42, 1024
    s_cselect_b32 s42, 0, s42
    s_cselect_b32 s43, 0, s43
L_k1_lloop:
    s_cmp_lt_u32 s40, 6
    s_cbranch_scc1 L_k1_wfull
    s_cmp_eq_u32 s40, 6
    s_cbranch_scc0 L_k1_w0
    s_waitcnt vmcnt(0)
    s_branch L_k1_wdone
L_k1_w0:
    s_waitcnt vmcnt(0)
    s_branch L_k1_wdone
L_k1_wfull:
    s_waitcnt vmcnt(8)
L_k1_wdone:
    s_barrier
    s_cmp_lt_u32 s40, 5
    s_cbranch_scc0 L_k1_noissue
    s_add_u32 s47, s41, s46
    s_add_u32 m0, s47, 0
    s_nop 0
    buffer_load_dwordx4 v8, s[12:15], s42 offen lds
    s_add_u32 m0, s47, 4096
    s_nop 0
    buffer_load_dwordx4 v204, s[12:15], s42 offen lds
    s_add_u32 m0, s47, 8192
    s_nop 0
    buffer_load_dwordx4 v205, s[12:15], s42 offen lds
    s_add_u32 m0, s47, 12288
    s_nop 0
    buffer_load_dwordx4 v206, s[12:15], s42 offen lds
    s_add_u32 m0, s47, 16384
    s_nop 0
    buffer_load_dwordx4 v207, s[12:15], s42 offen lds
    s_add_u32 m0, s47, 20480
    s_add_u32 s48, s43, 0
    buffer_load_dwordx4 v9, s[16:19], s48 offen lds
    s_add_u32 m0, s47, 24576
    s_add_u32 s48, s43, 0
    buffer_load_dwordx4 v10, s[16:19], s48 offen lds
    s_add_u32 m0, s47, 28672
    s_add_u32 s48, s43, 0
    buffer_load_dwordx4 v11, s[16:19], s48 offen lds
    s_add_u32 s41, s41, 32768
    s_cmp_ge_u32 s41, 98304
    s_cselect_b32 s41, 0, s41
    s_add_u32 s42, s42, 128
    s_add_u32 s43, s43, 196608
    s_cmp_ge_u32 s42, 1024
    s_cselect_b32 s42, 0, s42
    s_cselect_b32 s43, 0, s43
L_k1_noissue:
    s_add_u32 s40, s40, 1
    s_cmp_lt_u32 s40, 8
    s_cbranch_scc1 L_k1_lloop
    s_mov_b32 s52, s68
    s_and_b32 s53, s69, 0xffff
    s_mov_b32 s54, 524288
    s_mov_b32 s55, 0x00020000
    v_lshlrev_b32 v4, 4, v1
    s_lshl_b32 s3, s2, 11
    s_lshl_b32 s56, s26, 9
    s_add_u32 s3, s3, s56
    v_and_b32 v5, 0x1ff, v4
    buffer_load_dwordx4 v[64:67], v5, s[52:55], s3 offen
    s_mov_b32 s52, s72
    s_and_b32 s53, s73, 0xffff
    s_mov_b32 s54, 1835008
    s_mov_b32 s55, 0x00020000
    s_mov_b32 s56, s76
    s_and_b32 s57, s77, 0xffff
    s_mov_b32 s58, 1835008
    s_mov_b32 s59, 0x00020000
    s_mul_i32 s3, s2, 7168
    s_mul_i32 s60, s26, 1792
    s_add_u32 s3, s3, s60
    buffer_load_dwordx4 v[68:71], v4, s[52:55], s3 offen
    buffer_load_dwordx4 v[72:75], v4, s[52:55], s3 offen offset:768
    buffer_load_dwordx4 v[76:79], v4, s[56:59], s3 offen
    buffer_load_dwordx4 v[80:83], v4, s[56:59], s3 offen offset:768
    s_getpc_b64 s[56:57]
L_pc_here:
    s_add_u32 s56, s56, k2_wo_kernel - L_pc_here
    s_addc_u32 s57, s57, 0
    s_lshr_b32 s3, s2, 3
    s_lshl_b32 s3, s3, 2
    s_add_u32 s3, s3, s26
    s_lshl_b32 s3, s3, 10
    v_add_u32 v5, s3, v4
    v_min_u32 v5, L_code_end - k2_wo_kernel - 16, v5
    global_load_dwordx4 v[84:87], v5, s[56:57]
    s_barrier
    s_barrier
    s_waitcnt vmcnt(0)
    s_branch L_k1_attn
L_k1_compute:
    v_lshrrev_b32 v5, 1, v2
    v_mul_u32_u24 v6, 128, v2
    v_add_u32 v7, 0, v3
    v_xor_b32 v7, v7, v5
    v_lshl_add_u32 v12, v7, 4, v6
    v_add_u32 v7, 4, v3
    v_xor_b32 v7, v7, v5
    v_lshl_add_u32 v13, v7, 4, v6
    v_lshrrev_b32 v5, 2, v2
    v_and_b32 v6, 3, v2
    v_lshl_add_u32 v5, v3, 3, v5
    v_mul_u32_u24 v5, 192, v5
    v_lshl_add_u32 v5, v6, 3, v5
    v_add_u32 v5, 20480, v5
    v_and_b32 v6, 1, v3
    v_lshl_add_u32 v14, v6, 5, v5
    v_mul_u32_u24 v7, 160, v6
    v_sub_u32 v15, 160, v7
    v_add_u32 v15, v15, v5
    s_add_u32 s3, s26, 2
    v_add_u32 v7, s3, v6
    v_subrev_u32 v16, 6, v7
    v_min_u32 v7, v7, v16
    v_lshl_add_u32 v16, v7, 5, v5
    s_and_b32 s3, s26, 1
    v_add_u32 v7, s3, v6
    v_lshl_add_u32 v17, v7, 5, v5
    v_mov_b32 v208, 0
    v_mov_b32 v209, 0
    v_mov_b32 v210, 0
    v_mov_b32 v211, 0
    v_mov_b32 v212, 0
    v_mov_b32 v213, 0
    v_mov_b32 v214, 0
    v_mov_b32 v215, 0
    v_mov_b32 v216, 0
    v_mov_b32 v217, 0
    v_mov_b32 v218, 0
    v_mov_b32 v219, 0
    v_mov_b32 v220, 0
    v_mov_b32 v221, 0
    v_mov_b32 v222, 0
    v_mov_b32 v223, 0
    v_mov_b32 v224, 0
    v_mov_b32 v225, 0
    v_mov_b32 v226, 0
    v_mov_b32 v227, 0
    v_mov_b32 v228, 0
    v_mov_b32 v229, 0
    v_mov_b32 v230, 0
    v_mov_b32 v231, 0
    v_mov_b32 v232, 0x3f803f80
    v_mov_b32 v233, 0x3f803f80
    v_mov_b32 v234, 0x3f803f80
    v_mov_b32 v235, 0x3f803f80
    v_mov_b32 v24, 0x3f803f80
    v_cmp_eq_u32 s[34:35], 0, v2
    v_mov_b32 v32, 0
    v_mov_b32 v33, 0
    v_mov_b32 v34, 0
    v_mov_b32 v35, 0
    v_mov_b32 v36, 0
    v_mov_b32 v37, 0
    v_mov_b32 v38, 0
    v_mov_b32 v39, 0
    v_mov_b32 v40, 0
    v_mov_b32 v41, 0
    v_mov_b32 v42, 0
    v_mov_b32 v43, 0
    v_mov_b32 v44, 0
    v_mov_b32 v45, 0
    v_mov_b32 v46, 0
    v_mov_b32 v47, 0
    v_mov_b32 v48, 0
    v_mov_b32 v49, 0
    v_mov_b32 v50, 0
    v_mov_b32 v51, 0
    v_mov_b32 v52, 0
    v_mov_b32 v53, 0
    v_mov_b32 v54, 0
    v_mov_b32 v55, 0
    v_mov_b32 v56, 0
    v_mov_b32 v57, 0
    v_mov_b32 v58, 0
    v_mov_b32 v59, 0
    v_mov_b32 v60, 0
    v_mov_b32 v61, 0
    v_mov_b32 v62, 0
    v_mov_b32 v63, 0
    v_mov_b32 v64, 0
    v_mov_b32 v65, 0
    v_mov_b32 v66, 0
    v_mov_b32 v67, 0
    v_mov_b32 v68, 0
    v_mov_b32 v69, 0
    v_mov_b32 v70, 0
    v_mov_b32 v71, 0
    v_mov_b32 v72, 0
    v_mov_b32 v73, 0
    v_mov_b32 v74, 0
    v_mov_b32 v75, 0
    v_mov_b32 v76, 0
    v_mov_b32 v77, 0
    v_mov_b32 v78, 0
    v_mov_b32 v79, 0
    v_mov_b32 v80, 0
    v_mov_b32 v81, 0
    v_mov_b32 v82, 0
    v_mov_b32 v83, 0
    v_mov_b32 v84, 0
    v_mov_b32 v85, 0
    v_mov_b32 v86, 0
    v_mov_b32 v87, 0
    v_mov_b32 v176, 0
    v_mov_b32 v177, 0
    v_mov_b32 v178, 0
    v_mov_b32 v179, 0
    v_mov_b32 v180, 0
    v_mov_b32 v181, 0
    s_mul_i32 s3, s26, 4096
    v_add_u32 v25, s3, v12
    v_add_u32 v26, s3, v13
    v_mov_b32 v18, v12
    v_mov_b32 v19, v13
    v_mov_b32 v20, v14
    v_mov_b32 v21, v15
    v_mov_b32 v22, v16
    v_mov_b32 v23, v17
    v_mov_b32 v28, v25
    v_mov_b32 v29, v26
    s_barrier
    ds_read_b128 v[152:155], v28 offset:2048
    ds_read_b128 v[156:159], v28 offset:4096
    ds_read_b128 v[160:163], v18
    ds_read_b64_tr_b16 v[88:89], v20 offset:0
    ds_read_b64_tr_b16 v[90:91], v20 offset:768
    ds_read_b64_tr_b16 v[92:93], v20 offset:32
    ds_read_b64_tr_b16 v[94:95], v20 offset:800
    ds_read_b64_tr_b16 v[96:97], v20 offset:64
    ds_read_b64_tr_b16 v[98:99], v20 offset:832
    ds_read_b64_tr_b16 v[100:101], v20 offset:96
    ds_read_b64_tr_b16 v[102:103], v20 offset:864
    ds_read_b64_tr_b16 v[104:105], v20 offset:128
    ds_read_b64_tr_b16 v[106:107], v20 offset:896
    ds_read_b64_tr_b16 v[108:109], v21 offset:0
    ds_read_b64_tr_b16 v[110:111], v21 offset:768
    ds_read_b64_tr_b16 v[112:113], v22 offset:0
    ds_read_b64_tr_b16 v[114:115], v22 offset:768
    ds_read_b64_tr_b16 v[116:117], v23 offset:0
    ds_read_b64_tr_b16 v[118:119], v23 offset:768
    s_waitcnt lgkmcnt(0)
L_k1_loop:
    v_mfma_f32_16x16x32_bf16 v[224:227], v[232:235], v[160:163], v[224:227]
    ds_read_b128 v[164:167], v29 offset:2048
    ds_read_b128 v[168:171], v29 offset:4096
    v_mfma_f32_16x16x32_bf16 v[228:231], v[160:163], v[160:163], v[228:231]
    ds_read_b128 v[172:175], v19
    v_mfma_f32_16x16x32_bf16 v[208:211], v[232:235], v[152:155], v[208:211]
    ds_read_b64_tr_b16 v[120:121], v20 offset:6144
    v_mfma_f32_16x16x32_bf16 v[212:215], v[152:155], v[152:155], v[212:215]
    ds_read_b64_tr_b16 v[122:123], v20 offset:6912
    v_mfma_f32_16x16x32_bf16 v[216:219], v[232:235], v[156:159], v[216:219]
    ds_read_b64_tr_b16 v[124:125], v20 offset:6176
    v_mfma_f32_16x16x32_bf16 v[220:223], v[156:159], v[156:159], v[220:223]
    ds_read_b64_tr_b16 v[126:127], v20 offset:6944
    v_mfma_f32_16x16x32_bf16 v[32:35], v[88:91], v[152:155], v[32:35]
    ds_read_b64_tr_b16 v[128:129], v20 offset:6208
    v_mfma_f32_16x16x32_bf16 v[56:59], v[88:91], v[156:159], v[56:59]
    ds_read_b64_tr_b16 v[130:131], v20 offset:6976
    v_mfma_f32_16x16x32_bf16 v[36:39], v[92:95], v[152:155], v[36:39]
    ds_read_b64_tr_b16 v[132:133], v20 offset:6240
    v_mfma_f32_16x16x32_bf16 v[60:63], v[92:95], v[156:159], v[60:63]
    ds_read_b64_tr_b16 v[134:135], v20 offset:7008
    v_mfma_f32_16x16x32_bf16 v[40:43], v[96:99], v[152:155], v[40:43]
    ds_read_b64_tr_b16 v[136:137], v20 offset:6272
    v_mfma_f32_16x16x32_bf16 v[64:67], v[96:99], v[156:159], v[64:67]
    ds_read_b64_tr_b16 v[138:139], v20 offset:7040
    v_mfma_f32_16x16x32_bf16 v[44:47], v[100:103], v[152:155], v[44:47]
    ds_read_b64_tr_b16 v[140:141], v21 offset:6144
    v_mfma_f32_16x16x32_bf16 v[68:71], v[100:103], v[156:159], v[68:71]
    ds_read_b64_tr_b16 v[142:143], v21 offset:6912
    v_mfma_f32_16x16x32_bf16 v[48:51], v[104:107], v[152:155], v[48:51]
    ds_read_b64_tr_b16 v[144:145], v22 offset:6144
    v_mfma_f32_16x16x32_bf16 v[72:75], v[104:107], v[156:159], v[72:75]
    ds_read_b64_tr_b16 v[146:147], v22 offset:6912
    v_mfma_f32_16x16x32_bf16 v[52:55], v[108:111], v[152:155], v[52:55]
    ds_read_b64_tr_b16 v[148:149], v23 offset:6144
    v_mfma_f32_16x16x32_bf16 v[76:79], v[108:111], v[156:159], v[76:79]
    ds_read_b64_tr_b16 v[150:151], v23 offset:6912
    v_cndmask_b32 v160, v160, v24, s[34:35]
    v_cndmask_b32 v161, v161, v24, s[34:35]
    v_cndmask_b32 v162, v162, v24, s[34:35]
    v_cndmask_b32 v163, v163, v24, s[34:35]
    s_nop 1
    v_mfma_f32_16x16x32_bf16 v[80:83], v[112:115], v[160:163], v[80:83]
    v_mfma_f32_16x16x32_bf16 v[84:87], v[116:119], v[160:163], v[84:87]
    s_waitcnt lgkmcnt(0)
    s_barrier
    s_add_u32 s44, s44, 32768
    s_cmp_ge_u32 s44, 98304
    s_cselect_b32 s44, 0, s44
    v_add_u32 v18, s44, v12
    v_add_u32 v19, s44, v13
    v_add_u32 v20, s44, v14
    v_add_u32 v21, s44, v15
    v_add_u32 v22, s44, v16
    v_add_u32 v23, s44, v17
    v_add_u32 v28, s44, v25
    v_add_u32 v29, s44, v26
    v_mfma_f32_16x16x32_bf16 v[224:227], v[232:235], v[172:175], v[224:227]
    ds_read_b128 v[152:155], v28 offset:2048
    ds_read_b128 v[156:159], v28 offset:4096
    v_mfma_f32_16x16x32_bf16 v[228:231], v[172:175], v[172:175], v[228:231]
    ds_read_b128 v[160:163], v18
    v_mfma_f32_16x16x32_bf16 v[208:211], v[232:235], v[164:167], v[208:211]
    ds_read_b64_tr_b16 v[88:89], v20 offset:0
    v_mfma_f32_16x16x32_bf16 v[212:215], v[164:167], v[164:167], v[212:215]
    ds_read_b64_tr_b16 v[90:91], v20 offset:768
    v_mfma_f32_16x16x32_bf16 v[216:219], v[232:235], v[168:171], v[216:219]
    ds_read_b64_tr_b16 v[92:93], v20 offset:32
    v_mfma_f32_16x16x32_bf16 v[220:223], v[168:171], v[168:171], v[220:223]
    ds_read_b64_tr_b16 v[94:95], v20 offset:800
    v_mfma_f32_16x16x32_bf16 v[32:35], v[120:123], v[164:167], v[32:35]
    ds_read_b64_tr_b16 v[96:97], v20 offset:64
    v_mfma_f32_16x16x32_bf16 v[56:59], v[120:123], v[168:171], v[56:59]
    ds_read_b64_tr_b16 v[98:99], v20 offset:832
    v_mfma_f32_16x16x32_bf16 v[36:39], v[124:127], v[164:167], v[36:39]
    ds_read_b64_tr_b16 v[100:101], v20 offset:96
    v_mfma_f32_16x16x32_bf16 v[60:63], v[124:127], v[168:171], v[60:63]
    ds_read_b64_tr_b16 v[102:103], v20 offset:864
    v_mfma_f32_16x16x32_bf16 v[40:43], v[128:131], v[164:167], v[40:43]
    ds_read_b64_tr_b16 v[104:105], v20 offset:128
    v_mfma_f32_16x16x32_bf16 v[64:67], v[128:131], v[168:171], v[64:67]
    ds_read_b64_tr_b16 v[106:107], v20 offset:896
    v_mfma_f32_16x16x32_bf16 v[44:47], v[132:135], v[164:167], v[44:47]
    ds_read_b64_tr_b16 v[108:109], v21 offset:0
    v_mfma_f32_16x16x32_bf16 v[68:71], v[132:135], v[168:171], v[68:71]
    ds_read_b64_tr_b16 v[110:111], v21 offset:768
    v_mfma_f32_16x16x32_bf16 v[48:51], v[136:139], v[164:167], v[48:51]
    ds_read_b64_tr_b16 v[112:113], v22 offset:0
    v_mfma_f32_16x16x32_bf16 v[72:75], v[136:139], v[168:171], v[72:75]
    ds_read_b64_tr_b16 v[114:115], v22 offset:768
    v_mfma_f32_16x16x32_bf16 v[52:55], v[140:143], v[164:167], v[52:55]
    ds_read_b64_tr_b16 v[116:117], v23 offset:0
    v_mfma_f32_16x16x32_bf16 v[76:79], v[140:143], v[168:171], v[76:79]
    ds_read_b64_tr_b16 v[118:119], v23 offset:768
    v_cndmask_b32 v172, v172, v24, s[34:35]
    v_cndmask_b32 v173, v173, v24, s[34:35]
    v_cndmask_b32 v174, v174, v24, s[34:35]
    v_cndmask_b32 v175, v175, v24, s[34:35]
    s_nop 1
    v_mfma_f32_16x16x32_bf16 v[80:83], v[144:147], v[172:175], v[80:83]
    v_mfma_f32_16x16x32_bf16 v[84:87], v[148:151], v[172:175], v[84:87]
    s_waitcnt lgkmcnt(0)
    s_add_u32 s40, s40, 1
    s_cmp_lt_u32 s40, 8
    s_cbranch_scc1 L_k1_loop
    s_nop 7
    s_nop 7
    v_and_b32 v4, 3, v2
    v_cmp_eq_u32 s[36:37], 1, v4
    v_cmp_eq_u32 s[38:39], 2, v4
    v_cmp_eq_u32 vcc, 3, v4
    v_lshrrev_b32 v4, 2, v2
    v_lshl_add_u32 v4, v4, 4, v2
    v_lshlrev_b32 v4, 2, v4
    v_cndmask_b32 v212, v212, v213, s[36:37]
    v_cndmask_b32 v212, v212, v214, s[38:39]
    v_cndmask_b32 v212, v212, v215, vcc
    ds_bpermute_b32 v177, v4, v212
    v_mov_b32 v176, v208
    v_cndmask_b32 v220, v220, v221, s[36:37]
    v_cndmask_b32 v220, v220, v222, s[38:39]
    v_cndmask_b32 v220, v220, v223, vcc
    ds_bpermute_b32 v179, v4, v220
    v_mov_b32 v178, v216
    v_cndmask_b32 v228, v228, v229, s[36:37]
    v_cndmask_b32 v228, v228, v230, s[38:39]
    v_cndmask_b32 v228, v228, v231, vcc
    ds_bpermute_b32 v181, v4, v228
    v_mov_b32 v180, v224
    s_waitcnt lgkmcnt(0)
    v_mov_b32 v4, 0x3b000000
    v_mov_b32 v5, 0x3727c5ac
    v_mul_f32 v176, v176, v4
    v_mul_f32 v177, v177, v4
    v_fma_f32 v177, -v176, v176, v177
    v_max_f32 v177, 0, v177
    v_add_f32 v177, v177, v5
    v_rsq_f32 v177, v177
    s_nop 0
    v_mul_f32 v192, v176, v177
    v_mul_f32 v193, v176, v177
    v_mov_b32 v194, v177
    v_mov_b32 v195, v177
    v_mul_f32 v178, v178, v4
    v_mul_f32 v179, v179, v4
    v_fma_f32 v179, -v178, v178, v179
    v_max_f32 v179, 0, v179
    v_add_f32 v179, v179, v5
    v_rsq_f32 v179, v179
    s_nop 0
    v_mul_f32 v196, v178, v179
    v_mul_f32 v197, v178, v179
    v_mov_b32 v198, v179
    v_mov_b32 v199, v179
    v_mul_f32 v180, v180, v4
    v_mul_f32 v181, v181, v4
    v_fma_f32 v181, -v180, v180, v181
    v_max_f32 v181, 0, v181
    v_add_f32 v181, v181, v5
    v_rsq_f32 v181, v181
    s_nop 0
    v_mul_f32 v200, v180, v181
    v_mul_f32 v201, v180, v181
    v_mov_b32 v202, v181
    v_mov_b32 v203, v181
    v_lshlrev_b32 v6, 4, v3
    v_add_u32 v7, 131072, v6
    s_add_u32 s36, s26, 2
    s_lshl_b32 s36, s36, 6
    v_add_u32 v8, s36, v7
    s_and_b32 s37, s26, 1
    s_lshl_b32 s37, s37, 6
    v_add_u32 v9, s37, v7
    s_and_saveexec_b64 s[36:37], s[34:35]
    ds_write_b128 v8, v[80:83]
    ds_write_b128 v9, v[84:87]
    s_mov_b64 exec, s[36:37]
    s_waitcnt lgkmcnt(0)
    s_barrier
    ds_read_b128 v[88:91], v7 offset:0
    ds_read_b128 v[92:95], v7 offset:64
    ds_read_b128 v[96:99], v7 offset:128
    ds_read_b128 v[100:103], v7 offset:192
    ds_read_b128 v[104:107], v7 offset:256
    ds_read_b128 v[108:111], v7 offset:320
    ds_read_b128 v[112:115], v8
    s_lshl_b32 s36, s26, 5
    v_add_u32 v10, s36, v2
    v_mul_u32_u24 v10, 144, v10
    v_add_u32 v10, v10, v6
    v_mul_u32_u24 v11, 144, v2
    v_add_u32 v11, v11, v6
    s_cmp_lt_u32 s26, 2
    s_mov_b32 s37, 39168
    s_cselect_b32 s36, 18432, s37
    s_and_b32 s37, s26, 1
    s_lshl_b32 s37, s37, 6
    s_add_u32 s36, s36, s37
    v_add_u32 v11, s36, v11
    s_waitcnt lgkmcnt(0)
    v_pk_mul_f32 v[120:121], v[88:89], v[192:193]
    v_pk_mul_f32 v[122:123], v[90:91], v[192:193]
    v_pk_fma_f32 v[32:33], v[32:33], v[194:195], v[120:121] neg_lo:[0,0,1] neg_hi:[0,0,1]
    v_pk_fma_f32 v[34:35], v[34:35], v[194:195], v[122:123] neg_lo:[0,0,1] neg_hi:[0,0,1]
    ds_write_b128 v10, v[32:35] offset:0
    v_pk_mul_f32 v[120:121], v[92:93], v[192:193]
    v_pk_mul_f32 v[122:123], v[94:95], v[192:193]
    v_pk_fma_f32 v[36:37], v[36:37], v[194:195], v[120:121] neg_lo:[0,0,1] neg_hi:[0,0,1]
    v_pk_fma_f32 v[38:39], v[38:39], v[194:195], v[122:123] neg_lo:[0,0,1] neg_hi:[0,0,1]
    ds_write_b128 v10, v[36:39] offset:64
    v_pk_mul_f32 v[120:121], v[96:97], v[192:193]
    v_pk_mul_f32 v[122:123], v[98:99], v[192:193]
    v_pk_fma_f32 v[40:41], v[40:41], v[194:195], v[120:121] neg_lo:[0,0,1] neg_hi:[0,0,1]
    v_pk_fma_f32 v[42:43], v[42:43], v[194:195], v[122:123] neg_lo:[0,0,1] neg_hi:[0,0,1]
    ds_write_b128 v10, v[40:43] offset:20736
    v_pk_mul_f32 v[120:121], v[100:101], v[192:193]
    v_pk_mul_f32 v[122:123], v[102:103], v[192:193]
    v_pk_fma_f32 v[44:45], v[44:45], v[194:195], v[120:121] neg_lo:[0,0,1] neg_hi:[0,0,1]
    v_pk_fma_f32 v[46:47], v[46:47], v[194:195], v[122:123] neg_lo:[0,0,1] neg_hi:[0,0,1]
    ds_write_b128 v10, v[44:47] offset:20800
    v_pk_mul_f32 v[120:121], v[104:105], v[192:193]
    v_pk_mul_f32 v[122:123], v[106:107], v[192:193]
    v_pk_fma_f32 v[48:49], v[48:49], v[194:195], v[120:121] neg_lo:[0,0,1] neg_hi:[0,0,1]
    v_pk_fma_f32 v[50:51], v[50:51], v[194:195], v[122:123] neg_lo:[0,0,1] neg_hi:[0,0,1]
    ds_write_b128 v10, v[48:51] offset:41472
    v_pk_mul_f32 v[120:121], v[108:109], v[192:193]
    v_pk_mul_f32 v[122:123], v[110:111], v[192:193]
    v_pk_fma_f32 v[52:53], v[52:53], v[194:195], v[120:121] neg_lo:[0,0,1] neg_hi:[0,0,1]
    v_pk_fma_f32 v[54:55], v[54:55], v[194:195], v[122:123] neg_lo:[0,0,1] neg_hi:[0,0,1]
    ds_write_b128 v10, v[52:55] offset:41536
    v_pk_mul_f32 v[120:121], v[88:89], v[196:197]
    v_pk_mul_f32 v[122:123], v[90:91], v[196:197]
    v_pk_fma_f32 v[56:57], v[56:57], v[198:199], v[120:121] neg_lo:[0,0,1] neg_hi:[0,0,1]
    v_pk_fma_f32 v[58:59], v[58:59], v[198:199], v[122:123] neg_lo:[0,0,1] neg_hi:[0,0,1]
    ds_write_b128 v10, v[56:59] offset:2304
    v_pk_mul_f32 v[120:121], v[92:93], v[196:197]
    v_pk_mul_f32 v[122:123], v[94:95], v[196:197]
    v_pk_fma_f32 v[60:61], v[60:61], v[198:199], v[120:121] neg_lo:[0,0,1] neg_hi:[0,0,1]
    v_pk_fma_f32 v[62:63], v[62:63], v[198:199], v[122:123] neg_lo:[0,0,1] neg_hi:[0,0,1]
    ds_write_b128 v10, v[60:63] offset:2368
    v_pk_mul_f32 v[120:121], v[96:97], v[196:197]
    v_pk_mul_f32 v[122:123], v[98:99], v[196:197]
    v_pk_fma_f32 v[64:65], v[64:65], v[198:199], v[120:121] neg_lo:[0,0,1] neg_hi:[0,0,1]
    v_pk_fma_f32 v[66:67], v[66:67], v[198:199], v[122:123] neg_lo:[0,0,1] neg_hi:[0,0,1]
    ds_write_b128 v10, v[64:67] offset:23040
    v_pk_mul_f32 v[120:121], v[100:101], v[196:197]
    v_pk_mul_f32 v[122:123], v[102:103], v[196:197]
    v_pk_fma_f32 v[68:69], v[68:69], v[198:199], v[120:121] neg_lo:[0,0,1] neg_hi:[0,0,1]
    v_pk_fma_f32 v[70:71], v[70:71], v[198:199], v[122:123] neg_lo:[0,0,1] neg_hi:[0,0,1]
    ds_write_b128 v10, v[68:71] offset:23104
    v_pk_mul_f32 v[120:121], v[104:105], v[196:197]
    v_pk_mul_f32 v[122:123], v[106:107], v[196:197]
    v_pk_fma_f32 v[72:73], v[72:73], v[198:199], v[120:121] neg_lo:[0,0,1] neg_hi:[0,0,1]
    v_pk_fma_f32 v[74:75], v[74:75], v[198:199], v[122:123] neg_lo:[0,0,1] neg_hi:[0,0,1]
    ds_write_b128 v10, v[72:75] offset:43776
    v_pk_mul_f32 v[120:121], v[108:109], v[196:197]
    v_pk_mul_f32 v[122:123], v[110:111], v[196:197]
    v_pk_fma_f32 v[76:77], v[76:77], v[198:199], v[120:121] neg_lo:[0,0,1] neg_hi:[0,0,1]
    v_pk_fma_f32 v[78:79], v[78:79], v[198:199], v[122:123] neg_lo:[0,0,1] neg_hi:[0,0,1]
    ds_write_b128 v10, v[76:79] offset:43840
    v_pk_mul_f32 v[120:121], v[112:113], v[200:201]
    v_pk_mul_f32 v[122:123], v[114:115], v[200:201]
    v_pk_fma_f32 v[80:81], v[80:81], v[202:203], v[120:121] neg_lo:[0,0,1] neg_hi:[0,0,1]
    v_pk_fma_f32 v[82:83], v[82:83], v[202:203], v[122:123] neg_lo:[0,0,1] neg_hi:[0,0,1]
    ds_write_b128 v11, v[80:83] offset:0
    s_waitcnt lgkmcnt(0)
    s_barrier
L_k1_attn:
    v_bfe_u32 v4, v0, 1, 7
    v_lshrrev_b32 v5, 8, v0
    v_and_b32 v7, 1, v0
    v_mul_u32_u24 v6, 144, v4
    v_lshl_add_u32 v6, v5, 6, v6
    v_lshl_add_u32 v6, v7, 5, v6
    ds_read_b128 v[8:11], v6 offset:0
    ds_read_b128 v[12:15], v6 offset:16
    ds_read_b128 v[64:67], v6 offset:20736
    ds_read_b128 v[68:71], v6 offset:20752
    ds_read_b128 v[72:75], v6 offset:20448
    ds_read_b128 v[76:79], v6 offset:20464
    ds_read_b128 v[80:83], v6 offset:20160
    ds_read_b128 v[84:87], v6 offset:20176
    ds_read_b128 v[88:91], v6 offset:19872
    ds_read_b128 v[92:95], v6 offset:19888
    ds_read_b128 v[96:99], v6 offset:19584
    ds_read_b128 v[100:103], v6 offset:19600
    ds_read_b128 v[104:107], v6 offset:19296
    ds_read_b128 v[108:111], v6 offset:19312
    ds_read_b128 v[112:115], v6 offset:19008
    ds_read_b128 v[116:119], v6 offset:19024
    ds_read_b128 v[120:123], v6 offset:18720
    ds_read_b128 v[124:127], v6 offset:18736
    v_mov_b32 v40, 0x3eb8aa3b
    v_mov_b32 v41, 0x3eb8aa3b
    s_waitcnt lgkmcnt(15)
    s_waitcnt lgkmcnt(8)
    ds_read_b128 v[128:131], v6 offset:41472
    ds_read_b128 v[132:135], v6 offset:41488
    ds_read_b128 v[136:139], v6 offset:41184
    ds_read_b128 v[140:143], v6 offset:41200
    ds_read_b128 v[144:147], v6 offset:40896
    ds_read_b128 v[148:151], v6 offset:40912
    s_waitcnt lgkmcnt(6)
    ds_read_b128 v[152:155], v6 offset:40608
    ds_read_b128 v[156:159], v6 offset:40624
    ds_read_b128 v[160:163], v6 offset:40320
    ds_read_b128 v[164:167], v6 offset:40336
    ds_read_b128 v[168:171], v6 offset:40032
    ds_read_b128 v[172:175], v6 offset:40048
    ds_read_b128 v[176:179], v6 offset:39744
    ds_read_b128 v[180:183], v6 offset:39760
    ds_read_b128 v[184:187], v6 offset:39456
    ds_read_b128 v[188:191], v6 offset:39472
    v_pk_mul_f32 v[8:9], v[8:9], v[40:41]
    v_pk_mul_f32 v[10:11], v[10:11], v[40:41]
    v_pk_mul_f32 v[12:13], v[12:13], v[40:41]
    v_pk_mul_f32 v[14:15], v[14:15], v[40:41]
    v_pk_mul_f32 v[42:43], v[8:9], v[64:65]
    v_pk_mul_f32 v[44:45], v[8:9], v[72:73]
    v_pk_mul_f32 v[46:47], v[8:9], v[80:81]
    v_pk_mul_f32 v[48:49], v[8:9], v[88:89]
    v_pk_mul_f32 v[50:51], v[8:9], v[96:97]
    v_pk_mul_f32 v[52:53], v[8:9], v[104:105]
    v_pk_mul_f32 v[54:55], v[8:9], v[112:113]
    v_pk_mul_f32 v[56:57], v[8:9], v[120:121]
    v_pk_fma_f32 v[42:43], v[10:11], v[66:67], v[42:43]
    v_pk_fma_f32 v[44:45], v[10:11], v[74:75], v[44:45]
    v_pk_fma_f32 v[46:47], v[10:11], v[82:83], v[46:47]
    v_pk_fma_f32 v[48:49], v[10:11], v[90:91], v[48:49]
    v_pk_fma_f32 v[50:51], v[10:11], v[98:99], v[50:51]
    v_pk_fma_f32 v[52:53], v[10:11], v[106:107], v[52:53]
    v_pk_fma_f32 v[54:55], v[10:11], v[114:115], v[54:55]
    v_pk_fma_f32 v[56:57], v[10:11], v[122:123], v[56:57]
    v_pk_fma_f32 v[42:43], v[12:13], v[68:69], v[42:43]
    v_pk_fma_f32 v[44:45], v[12:13], v[76:77], v[44:45]
    v_pk_fma_f32 v[46:47], v[12:13], v[84:85], v[46:47]
    v_pk_fma_f32 v[48:49], v[12:13], v[92:93], v[48:49]
    v_pk_fma_f32 v[50:51], v[12:13], v[100:101], v[50:51]
    v_pk_fma_f32 v[52:53], v[12:13], v[108:109], v[52:53]
    v_pk_fma_f32 v[54:55], v[12:13], v[116:117], v[54:55]
    v_pk_fma_f32 v[56:57], v[12:13], v[124:125], v[56:57]
    v_pk_fma_f32 v[42:43], v[14:15], v[70:71], v[42:43]
    v_pk_fma_f32 v[44:45], v[14:15], v[78:79], v[44:45]
    v_pk_fma_f32 v[46:47], v[14:15], v[86:87], v[46:47]
    v_pk_fma_f32 v[48:49], v[14:15], v[94:95], v[48:49]
    v_pk_fma_f32 v[50:51], v[14:15], v[102:103], v[50:51]
    v_pk_fma_f32 v[52:53], v[14:15], v[110:111], v[52:53]
    v_pk_fma_f32 v[54:55], v[14:15], v[118:119], v[54:55]
    v_pk_fma_f32 v[56:57], v[14:15], v[126:127], v[56:57]
    v_add_f32 v24, v42, v43
    v_add_f32 v25, v44, v45
    v_add_f32 v26, v46, v47
    v_add_f32 v27, v48, v49
    v_add_f32 v28, v50, v51
    v_add_f32 v29, v52, v53
    v_add_f32 v30, v54, v55
    v_add_f32 v31, v56, v57
    s_nop 1
    v_add_f32_dpp v42, v24, v24 quad_perm:[1,0,3,2] row_mask:0xf bank_mask:0xf
    v_add_f32_dpp v43, v25, v25 quad_perm:[1,0,3,2] row_mask:0xf bank_mask:0xf
    v_add_f32_dpp v44, v26, v26 quad_perm:[1,0,3,2] row_mask:0xf bank_mask:0xf
    v_add_f32_dpp v45, v27, v27 quad_perm:[1,0,3,2] row_mask:0xf bank_mask:0xf
    v_add_f32_dpp v46, v28, v28 quad_perm:[1,0,3,2] row_mask:0xf bank_mask:0xf
    v_add_f32_dpp v47, v29, v29 quad_perm:[1,0,3,2] row_mask:0xf bank_mask:0xf
    v_add_f32_dpp v48, v30, v30 quad_perm:[1,0,3,2] row_mask:0xf bank_mask:0xf
    v_add_f32_dpp v49, v31, v31 quad_perm:[1,0,3,2] row_mask:0xf bank_mask:0xf
    v_add_u32 v32, s27, v4
    v_mov_b32 v33, 0xf149f2ca
    v_mov_b32 v24, v42
    v_cmp_le_u32 vcc, 2, v32
    s_nop 1
    v_cndmask_b32 v25, v33, v43, vcc
    v_cmp_le_u32 vcc, 4, v32
    s_nop 1
    v_cndmask_b32 v26, v33, v44, vcc
    v_cmp_le_u32 vcc, 6, v32
    s_nop 1
    v_cndmask_b32 v27, v33, v45, vcc
    v_cmp_le_u32 vcc, 8, v32
    s_nop 1
    v_cndmask_b32 v28, v33, v46, vcc
    v_cmp_le_u32 vcc, 10, v32
    s_nop 1
    v_cndmask_b32 v29, v33, v47, vcc
    v_cmp_le_u32 vcc, 12, v32
    s_nop 1
    v_cndmask_b32 v30, v33, v48, vcc
    v_cmp_le_u32 vcc, 14, v32
    s_nop 1
    v_cndmask_b32 v31, v33, v49, vcc
    v_max3_f32 v34, v24, v25, v26
    v_max3_f32 v34, v34, v27, v28
    v_max3_f32 v34, v34, v29, v30
    v_max_f32 v34, v34, v31
    v_sub_f32 v24, v24, v34
    v_sub_f32 v25, v25, v34
    v_sub_f32 v26, v26, v34
    v_sub_f32 v27, v27, v34
    v_sub_f32 v28, v28, v34
    v_sub_f32 v29, v29, v34
    v_sub_f32 v30, v30, v34
    v_sub_f32 v31, v31, v34
    v_exp_f32 v24, v24
    v_exp_f32 v25, v25
    v_exp_f32 v26, v26
    v_exp_f32 v27, v27
    v_exp_f32 v28, v28
    v_exp_f32 v29, v29
    v_exp_f32 v30, v30
    v_exp_f32 v31, v31
    s_nop 0
    v_add_f32 v35, v24, v25
    v_add_f32 v35, v35, v26
    v_add_f32 v35, v35, v27
    v_add_f32 v35, v35, v28
    v_add_f32 v35, v35, v29
    v_add_f32 v35, v35, v30
    v_add_f32 v35, v35, v31
    v_rcp_f32 v35, v35
    s_nop 0
    v_mul_f32 v44, v24, v35
    v_mul_f32 v46, v25, v35
    v_mul_f32 v48, v26, v35
    v_mul_f32 v50, v27, v35
    v_mul_f32 v52, v28, v35
    v_mul_f32 v54, v29, v35
    v_mul_f32 v56, v30, v35
    v_mul_f32 v58, v31, v35
    s_waitcnt lgkmcnt(0)
    v_pk_mul_f32 v[8:9], v[44:45], v[128:129] op_sel_hi:[0,1]
    v_pk_mul_f32 v[10:11], v[44:45], v[130:131] op_sel_hi:[0,1]
    v_pk_mul_f32 v[12:13], v[44:45], v[132:133] op_sel_hi:[0,1]
    v_pk_mul_f32 v[14:15], v[44:45], v[134:135] op_sel_hi:[0,1]
    v_pk_fma_f32 v[8:9], v[46:47], v[136:137], v[8:9] op_sel_hi:[0,1,1]
    v_pk_fma_f32 v[10:11], v[46:47], v[138:139], v[10:11] op_sel_hi:[0,1,1]
    v_pk_fma_f32 v[12:13], v[46:47], v[140:141], v[12:13] op_sel_hi:[0,1,1]
    v_pk_fma_f32 v[14:15], v[46:47], v[142:143], v[14:15] op_sel_hi:[0,1,1]
    v_pk_fma_f32 v[8:9], v[48:49], v[144:145], v[8:9] op_sel_hi:[0,1,1]
    v_pk_fma_f32 v[10:11], v[48:49], v[146:147], v[10:11] op_sel_hi:[0,1,1]
    v_pk_fma_f32 v[12:13], v[48:49], v[148:149], v[12:13] op_sel_hi:[0,1,1]
    v_pk_fma_f32 v[14:15], v[48:49], v[150:151], v[14:15] op_sel_hi:[0,1,1]
    v_pk_fma_f32 v[8:9], v[50:51], v[152:153], v[8:9] op_sel_hi:[0,1,1]
    v_pk_fma_f32 v[10:11], v[50:51], v[154:155], v[10:11] op_sel_hi:[0,1,1]
    v_pk_fma_f32 v[12:13], v[50:51], v[156:157], v[12:13] op_sel_hi:[0,1,1]
    v_pk_fma_f32 v[14:15], v[50:51], v[158:159], v[14:15] op_sel_hi:[0,1,1]
    v_pk_fma_f32 v[8:9], v[52:53], v[160:161], v[8:9] op_sel_hi:[0,1,1]
    v_pk_fma_f32 v[10:11], v[52:53], v[162:163], v[10:11] op_sel_hi:[0,1,1]
    v_pk_fma_f32 v[12:13], v[52:53], v[164:165], v[12:13] op_sel_hi:[0,1,1]
    v_pk_fma_f32 v[14:15], v[52:53], v[166:167], v[14:15] op_sel_hi:[0,1,1]
    v_pk_fma_f32 v[8:9], v[54:55], v[168:169], v[8:9] op_sel_hi:[0,1,1]
    v_pk_fma_f32 v[10:11], v[54:55], v[170:171], v[10:11] op_sel_hi:[0,1,1]
    v_pk_fma_f32 v[12:13], v[54:55], v[172:173], v[12:13] op_sel_hi:[0,1,1]
    v_pk_fma_f32 v[14:15], v[54:55], v[174:175], v[14:15] op_sel_hi:[0,1,1]
    v_pk_fma_f32 v[8:9], v[56:57], v[176:177], v[8:9] op_sel_hi:[0,1,1]
    v_pk_fma_f32 v[10:11], v[56:57], v[178:179], v[10:11] op_sel_hi:[0,1,1]
    v_pk_fma_f32 v[12:13], v[56:57], v[180:181], v[12:13] op_sel_hi:[0,1,1]
    v_pk_fma_f32 v[14:15], v[56:57], v[182:183], v[14:15] op_sel_hi:[0,1,1]
    v_pk_fma_f32 v[8:9], v[58:59], v[184:185], v[8:9] op_sel_hi:[0,1,1]
    v_pk_fma_f32 v[10:11], v[58:59], v[186:187], v[10:11] op_sel_hi:[0,1,1]
    v_pk_fma_f32 v[12:13], v[58:59], v[188:189], v[12:13] op_sel_hi:[0,1,1]
    v_pk_fma_f32 v[14:15], v[58:59], v[190:191], v[14:15] op_sel_hi:[0,1,1]
    v_cvt_pk_bf16_f32 v24, v8, v9
    v_cvt_pk_bf16_f32 v25, v10, v11
    v_cvt_pk_bf16_f32 v26, v12, v13
    v_cvt_pk_bf16_f32 v27, v14, v15
    v_lshlrev_b32 v32, 10, v32
    v_lshl_add_u32 v32, v5, 5, v32
    v_lshl_add_u32 v32, v7, 4, v32
    v_add_u32 v32, s30, v32
    buffer_store_dwordx4 v[24:27], v32, s[20:23], 0 offen
L_k1_done:
    s_endpgm
.globl k2_wo_kernel
.p2align 8
.type k2_wo_kernel,@function
k2_wo_kernel:
    s_cmp_ge_u32 s2, 256
    s_cbranch_scc1 L_k2_wo_kernel_done
    s_load_dwordx16 s[64:79], s[0:1], 0
    s_load_dwordx4 s[80:83], s[0:1], 64
    s_load_dwordx2 s[84:85], s[0:1], 80
    v_and_b32 v1, 63, v0
    v_lshrrev_b32 v4, 6, v0
    v_and_b32 v2, 15, v0
    v_bfe_u32 v3, v0, 4, 2
    v_readfirstlane_b32 s26, v4
    s_waitcnt lgkmcnt(0)
    s_lshr_b32 s51, s26, 2
    s_and_b32 s26, s26, 3
    s_and_b32 s24, s2, 7
    s_lshl_b32 s24, s24, 2
    s_lshr_b32 s25, s2, 6
    s_add_u32 s24, s24, s25
    s_bfe_u32 s25, s2, 0x30003
    s_mov_b32 s12, s84
    s_and_b32 s13, s85, 0xffff
    s_mov_b32 s14, 2097152
    s_mov_b32 s15, 0x00020000
    s_mov_b32 s16, s68
    s_and_b32 s17, s69, 0xffff
    s_mov_b32 s18, 524288
    s_mov_b32 s19, 0x00020000
    s_mov_b32 s20, s64
    s_and_b32 s21, s65, 0xffff
    s_mov_b32 s22, 2097152
    s_mov_b32 s23, 0x00020000
    s_add_u32 s36, s84, 2097152
    s_addc_u32 s37, s85, 0
    s_and_b32 s37, s37, 0xffff
    s_mov_b32 s38, 2097152
    s_mov_b32 s39, 0x00020000
    s_lshr_b32 s27, s26, 1
    s_and_b32 s28, s26, 1
    s_lshl_b32 s29, s24, 6
    v_lshrrev_b32 v5, 4, v1
    v_and_b32 v6, 15, v1
    s_lshl_b32 s3, s26, 2
    v_add_u32 v7, s3, v5
    v_xor_b32 v6, v6, v7
    s_mul_i32 s3, s26, 4
    s_add_u32 s3, s3, s29
    v_add_u32 v5, s3, v5
    s_mov_b32 s3, 1024
    v_mul_lo_u32 v5, v5, s3
    v_lshl_add_u32 v8, v6, 4, v5
    v_lshrrev_b32 v5, 3, v1
    v_bfe_u32 v6, v1, 1, 2
    v_bfe_u32 v7, v1, 4, 1
    s_lshl_b32 s3, s28, 1
    v_or_b32 v7, s3, v7
    v_xor_b32 v6, v6, v7
    v_and_b32 v7, 1, v1
    v_lshlrev_b32 v7, 4, v7
    v_lshl_add_u32 v7, v6, 5, v7
    s_lshl_b32 s3, s26, 3
    v_add_u32 v5, s3, v5
    v_lshl_add_u32 v7, v5, 10, v7
    s_lshl_b32 s3, s25, 7
    v_add_u32 v9, s3, v7
    s_mov_b32 s40, 0
    s_mov_b32 s41, 0
    s_mov_b32 s42, 0
    s_mov_b32 s43, 0
    s_mov_b32 s44, 0
    s_lshl_b32 s46, s26, 10
    s_cmp_eq_u32 s51, 0
    s_cbranch_scc1 L_k2_wo_kernel_compute
L_k2_wo_kernel_loader:
    s_add_u32 s47, s41, s46
    s_add_u32 m0, s47, 0
    s_add_u32 s48, s42, 0
    buffer_load_dwordx4 v8, s[12:15], s48 offen lds
    s_add_u32 m0, s47, 4096
    s_add_u32 s48, s42, 16384
    buffer_load_dwordx4 v8, s[12:15], s48 offen lds
    s_add_u32 m0, s47, 8192
    s_add_u32 s48, s42, 32768
    buffer_load_dwordx4 v8, s[12:15], s48 offen lds
    s_add_u32 m0, s47, 12288
    s_add_u32 s48, s42, 49152
    buffer_load_dwordx4 v8, s[12:15], s48 offen lds
    s_add_u32 m0, s47, 16384
    s_add_u32 s48, s43, 0
    buffer_load_dwordx4 v9, s[16:19], s48 offen lds
    s_add_u32 m0, s47, 20480
    s_add_u32 s48, s43, 32768
    buffer_load_dwordx4 v9, s[16:19], s48 offen lds
    s_add_u32 m0, s47, 24576
    s_add_u32 s48, s43, 65536
    buffer_load_dwordx4 v9, s[16:19], s48 offen lds
    s_add_u32 m0, s47, 28672
    s_add_u32 s48, s43, 98304
    buffer_load_dwordx4 v9, s[16:19], s48 offen lds
    s_add_u32 s41, s41, 32768
    s_cmp_ge_u32 s41, 131072
    s_cselect_b32 s41, 0, s41
    s_add_u32 s42, s42, 256
    s_add_u32 s43, s43, 131072
    s_cmp_ge_u32 s42, 1024
    s_cselect_b32 s42, 0, s42
    s_cselect_b32 s43, 0, s43
    s_add_u32 s47, s41, s46
    s_add_u32 m0, s47, 0
    s_add_u32 s48, s42, 0
    buffer_load_dwordx4 v8, s[12:15], s48 offen lds
    s_add_u32 m0, s47, 4096
    s_add_u32 s48, s42, 16384
    buffer_load_dwordx4 v8, s[12:15], s48 offen lds
    s_add_u32 m0, s47, 8192
    s_add_u32 s48, s42, 32768
    buffer_load_dwordx4 v8, s[12:15], s48 offen lds
    s_add_u32 m0, s47, 12288
    s_add_u32 s48, s42, 49152
    buffer_load_dwordx4 v8, s[12:15], s48 offen lds
    s_add_u32 m0, s47, 16384
    s_add_u32 s48, s43, 0
    buffer_load_dwordx4 v9, s[16:19], s48 offen lds
    s_add_u32 m0, s47, 20480
    s_add_u32 s48, s43, 32768
    buffer_load_dwordx4 v9, s[16:19], s48 offen lds
    s_add_u32 m0, s47, 24576
    s_add_u32 s48, s43, 65536
    buffer_load_dwordx4 v9, s[16:19], s48 offen lds
    s_add_u32 m0, s47, 28672
    s_add_u32 s48, s43, 98304
    buffer_load_dwordx4 v9, s[16:19], s48 offen lds
    s_add_u32 s41, s41, 32768
    s_cmp_ge_u32 s41, 131072
    s_cselect_b32 s41, 0, s41
    s_add_u32 s42, s42, 256
    s_add_u32 s43, s43, 131072
    s_cmp_ge_u32 s42, 1024
    s_cselect_b32 s42, 0, s42
    s_cselect_b32 s43, 0, s43
    s_waitcnt vmcnt(8)
    s_barrier
    s_add_u32 s47, s41, s46
    s_add_u32 m0, s47, 0
    s_add_u32 s48, s42, 0
    buffer_load_dwordx4 v8, s[12:15], s48 offen lds
    s_add_u32 m0, s47, 4096
    s_add_u32 s48, s42, 16384
    buffer_load_dwordx4 v8, s[12:15], s48 offen lds
    s_add_u32 m0, s47, 8192
    s_add_u32 s48, s42, 32768
    buffer_load_dwordx4 v8, s[12:15], s48 offen lds
    s_add_u32 m0, s47, 12288
    s_add_u32 s48, s42, 49152
    buffer_load_dwordx4 v8, s[12:15], s48 offen lds
    s_add_u32 m0, s47, 16384
    s_add_u32 s48, s43, 0
    buffer_load_dwordx4 v9, s[16:19], s48 offen lds
    s_add_u32 m0, s47, 20480
    s_add_u32 s48, s43, 32768
    buffer_load_dwordx4 v9, s[16:19], s48 offen lds
    s_add_u32 m0, s47, 24576
    s_add_u32 s48, s43, 65536
    buffer_load_dwordx4 v9, s[16:19], s48 offen lds
    s_add_u32 m0, s47, 28672
    s_add_u32 s48, s43, 98304
    buffer_load_dwordx4 v9, s[16:19], s48 offen lds
    s_add_u32 s41, s41, 32768
    s_cmp_ge_u32 s41, 131072
    s_cselect_b32 s41, 0, s41
    s_add_u32 s42, s42, 256
    s_add_u32 s43, s43, 131072
    s_cmp_ge_u32 s42, 1024
    s_cselect_b32 s42, 0, s42
    s_cselect_b32 s43, 0, s43
    s_add_u32 s47, s41, s46
    s_add_u32 m0, s47, 0
    s_add_u32 s48, s42, 0
    buffer_load_dwordx4 v8, s[12:15], s48 offen lds
    s_add_u32 m0, s47, 4096
    s_add_u32 s48, s42, 16384
    buffer_load_dwordx4 v8, s[12:15], s48 offen lds
    s_add_u32 m0, s47, 8192
    s_add_u32 s48, s42, 32768
    buffer_load_dwordx4 v8, s[12:15], s48 offen lds
    s_add_u32 m0, s47, 12288
    s_add_u32 s48, s42, 49152
    buffer_load_dwordx4 v8, s[12:15], s48 offen lds
    s_add_u32 m0, s47, 16384
    s_add_u32 s48, s43, 0
    buffer_load_dwordx4 v9, s[16:19], s48 offen lds
    s_add_u32 m0, s47, 20480
    s_add_u32 s48, s43, 32768
    buffer_load_dwordx4 v9, s[16:19], s48 offen lds
    s_add_u32 m0, s47, 24576
    s_add_u32 s48, s43, 65536
    buffer_load_dwordx4 v9, s[16:19], s48 offen lds
    s_add_u32 m0, s47, 28672
    s_add_u32 s48, s43, 98304
    buffer_load_dwordx4 v9, s[16:19], s48 offen lds
    s_add_u32 s41, s41, 32768
    s_cmp_ge_u32 s41, 131072
    s_cselect_b32 s41, 0, s41
    s_add_u32 s42, s42, 256
    s_add_u32 s43, s43, 131072
    s_cmp_ge_u32 s42, 1024
    s_cselect_b32 s42, 0, s42
    s_cselect_b32 s43, 0, s43
L_k2_wo_kernel_lloop:
    s_cmp_lt_u32 s40, 1
    s_cbranch_scc1 L_k2_wo_kernel_wfull
    s_cmp_eq_u32 s40, 1
    s_cbranch_scc0 L_k2_wo_kernel_w1
    s_waitcnt vmcnt(8)
    s_branch L_k2_wo_kernel_wdone
L_k2_wo_kernel_w1:
    s_cmp_eq_u32 s40, 2
    s_cbranch_scc0 L_k2_wo_kernel_w0
    s_waitcnt vmcnt(0)
    s_branch L_k2_wo_kernel_wdone
L_k2_wo_kernel_w0:
    s_waitcnt vmcnt(0)
    s_branch L_k2_wo_kernel_wdone
L_k2_wo_kernel_wfull:
    s_waitcnt vmcnt(16)
L_k2_wo_kernel_wdone:
    s_barrier
    s_cmp_lt_u32 s40, 0
    s_cbranch_scc0 L_k2_wo_kernel_noissue
    s_add_u32 s47, s41, s46
    s_add_u32 m0, s47, 0
    s_add_u32 s48, s42, 0
    buffer_load_dwordx4 v8, s[12:15], s48 offen lds
    s_add_u32 m0, s47, 4096
    s_add_u32 s48, s42, 16384
    buffer_load_dwordx4 v8, s[12:15], s48 offen lds
    s_add_u32 m0, s47, 8192
    s_add_u32 s48, s42, 32768
    buffer_load_dwordx4 v8, s[12:15], s48 offen lds
    s_add_u32 m0, s47, 12288
    s_add_u32 s48, s42, 49152
    buffer_load_dwordx4 v8, s[12:15], s48 offen lds
    s_add_u32 m0, s47, 16384
    s_add_u32 s48, s43, 0
    buffer_load_dwordx4 v9, s[16:19], s48 offen lds
    s_add_u32 m0, s47, 20480
    s_add_u32 s48, s43, 32768
    buffer_load_dwordx4 v9, s[16:19], s48 offen lds
    s_add_u32 m0, s47, 24576
    s_add_u32 s48, s43, 65536
    buffer_load_dwordx4 v9, s[16:19], s48 offen lds
    s_add_u32 m0, s47, 28672
    s_add_u32 s48, s43, 98304
    buffer_load_dwordx4 v9, s[16:19], s48 offen lds
    s_add_u32 s41, s41, 32768
    s_cmp_ge_u32 s41, 131072
    s_cselect_b32 s41, 0, s41
    s_add_u32 s42, s42, 256
    s_add_u32 s43, s43, 131072
    s_cmp_ge_u32 s42, 1024
    s_cselect_b32 s42, 0, s42
    s_cselect_b32 s43, 0, s43
L_k2_wo_kernel_noissue:
    s_add_u32 s40, s40, 1
    s_cmp_lt_u32 s40, 4
    s_cbranch_scc1 L_k2_wo_kernel_lloop
    s_barrier
    s_barrier
    s_endpgm
L_k2_wo_kernel_compute:
    s_lshl_b32 s30, s26, 4
    s_add_u32 s30, s30, s29
    v_lshrrev_b32 v5, 3, v1
    v_add_u32 v5, s30, v5
    v_and_b32 v6, 7, v1
    v_lshlrev_b32 v6, 4, v6
    s_lshl_b32 s30, s25, 7
    v_add_u32 v12, s30, v6
    v_lshl_add_u32 v10, v5, 10, v12
    v_add_u32 v11, 0x2000, v10
    buffer_load_dwordx4 v[96:99], v10, s[20:23], 0 offen
    buffer_load_dwordx4 v[100:103], v11, s[20:23], 0 offen
    v_mov_b32 v5, v2
    v_mul_u32_u24 v6, 256, v2
    v_add_u32 v7, 0, v3
    v_xor_b32 v7, v7, v5
    v_lshl_add_u32 v13, v7, 4, v6
    v_add_u32 v7, 4, v3
    v_xor_b32 v7, v7, v5
    v_lshl_add_u32 v14, v7, 4, v6
    v_add_u32 v7, 8, v3
    v_xor_b32 v7, v7, v5
    v_lshl_add_u32 v15, v7, 4, v6
    v_add_u32 v7, 12, v3
    v_xor_b32 v7, v7, v5
    v_lshl_add_u32 v16, v7, 4, v6
    s_mul_i32 s3, s27, 8192
    v_add_u32 v13, s3, v13
    v_add_u32 v14, s3, v14
    v_add_u32 v15, s3, v15
    v_add_u32 v16, s3, v16
    v_lshrrev_b32 v5, 2, v2
    v_and_b32 v6, 3, v2
    v_lshl_add_u32 v7, v3, 3, v5
    v_lshlrev_b32 v7, 7, v7
    v_lshl_add_u32 v7, v6, 3, v7
    v_add_u32 v7, 16384, v7
    v_lshrrev_b32 v5, 1, v5
    v_and_b32 v6, 1, v3
    v_lshl_add_u32 v5, v6, 1, v5
    s_lshl_b32 s3, s28, 1
    v_xor_b32 v6, s3, v5
    v_lshl_add_u32 v17, v6, 5, v7
    v_xor_b32 v6, 1, v6
    v_lshl_add_u32 v18, v6, 5, v7
    v_mov_b32 v32, 0
    v_mov_b32 v33, 0
    v_mov_b32 v34, 0
    v_mov_b32 v35, 0
    v_mov_b32 v36, 0
    v_mov_b32 v37, 0
    v_mov_b32 v38, 0
    v_mov_b32 v39, 0
    v_mov_b32 v40, 0
    v_mov_b32 v41, 0
    v_mov_b32 v42, 0
    v_mov_b32 v43, 0
    v_mov_b32 v44, 0
    v_mov_b32 v45, 0
    v_mov_b32 v46, 0
    v_mov_b32 v47, 0
    v_mov_b32 v20, v13
    v_mov_b32 v21, v14
    v_mov_b32 v22, v15
    v_mov_b32 v23, v16
    v_mov_b32 v24, v17
    v_mov_b32 v25, v18
    s_barrier
    ds_read_b128 v[64:67], v20 offset:0
    ds_read_b128 v[68:71], v20 offset:4096
    ds_read_b64_tr_b16 v[48:49], v24 offset:0
    ds_read_b64_tr_b16 v[50:51], v24 offset:512
    ds_read_b64_tr_b16 v[52:53], v25 offset:0
    ds_read_b64_tr_b16 v[54:55], v25 offset:512
    s_waitcnt lgkmcnt(0)
L_k2_wo_kernel_loop:
    v_mfma_f32_16x16x32_bf16 v[32:35], v[48:51], v[64:67], v[32:35]
    ds_read_b128 v[72:75], v21 offset:0
    ds_read_b128 v[76:79], v21 offset:4096
    v_mfma_f32_16x16x32_bf16 v[36:39], v[52:55], v[64:67], v[36:39]
    ds_read_b64_tr_b16 v[56:57], v24 offset:4096
    v_mfma_f32_16x16x32_bf16 v[40:43], v[48:51], v[68:71], v[40:43]
    ds_read_b64_tr_b16 v[58:59], v24 offset:4608
    ds_read_b64_tr_b16 v[60:61], v25 offset:4096
    v_mfma_f32_16x16x32_bf16 v[44:47], v[52:55], v[68:71], v[44:47]
    ds_read_b64_tr_b16 v[62:63], v25 offset:4608
    s_waitcnt lgkmcnt(0)
    v_mfma_f32_16x16x32_bf16 v[32:35], v[56:59], v[72:75], v[32:35]
    ds_read_b128 v[64:67], v22 offset:0
    ds_read_b128 v[68:71], v22 offset:4096
    v_mfma_f32_16x16x32_bf16 v[36:39], v[60:63], v[72:75], v[36:39]
    ds_read_b64_tr_b16 v[48:49], v24 offset:8192
    v_mfma_f32_16x16x32_bf16 v[40:43], v[56:59], v[76:79], v[40:43]
    ds_read_b64_tr_b16 v[50:51], v24 offset:8704
    ds_read_b64_tr_b16 v[52:53], v25 offset:8192
    v_mfma_f32_16x16x32_bf16 v[44:47], v[60:63], v[76:79], v[44:47]
    ds_read_b64_tr_b16 v[54:55], v25 offset:8704
    s_waitcnt lgkmcnt(0)
    v_mfma_f32_16x16x32_bf16 v[32:35], v[48:51], v[64:67], v[32:35]
    ds_read_b128 v[72:75], v23 offset:0
    ds_read_b128 v[76:79], v23 offset:4096
    v_mfma_f32_16x16x32_bf16 v[36:39], v[52:55], v[64:67], v[36:39]
    ds_read_b64_tr_b16 v[56:57], v24 offset:12288
    v_mfma_f32_16x16x32_bf16 v[40:43], v[48:51], v[68:71], v[40:43]
    ds_read_b64_tr_b16 v[58:59], v24 offset:12800
    ds_read_b64_tr_b16 v[60:61], v25 offset:12288
    v_mfma_f32_16x16x32_bf16 v[44:47], v[52:55], v[68:71], v[44:47]
    ds_read_b64_tr_b16 v[62:63], v25 offset:12800
    s_waitcnt lgkmcnt(0)
    s_barrier
    s_add_u32 s44, s44, 32768
    s_cmp_ge_u32 s44, 131072
    s_cselect_b32 s44, 0, s44
    v_add_u32 v20, s44, v13
    v_add_u32 v21, s44, v14
    v_add_u32 v22, s44, v15
    v_add_u32 v23, s44, v16
    v_add_u32 v24, s44, v17
    v_add_u32 v25, s44, v18
    v_mfma_f32_16x16x32_bf16 v[32:35], v[56:59], v[72:75], v[32:35]
    ds_read_b128 v[64:67], v20 offset:0
    ds_read_b128 v[68:71], v20 offset:4096
    v_mfma_f32_16x16x32_bf16 v[36:39], v[60:63], v[72:75], v[36:39]
    ds_read_b64_tr_b16 v[48:49], v24 offset:0
    v_mfma_f32_16x16x32_bf16 v[40:43], v[56:59], v[76:79], v[40:43]
    ds_read_b64_tr_b16 v[50:51], v24 offset:512
    ds_read_b64_tr_b16 v[52:53], v25 offset:0
    v_mfma_f32_16x16x32_bf16 v[44:47], v[60:63], v[76:79], v[44:47]
    ds_read_b64_tr_b16 v[54:55], v25 offset:512
    s_waitcnt lgkmcnt(0)
    s_add_u32 s40, s40, 1
    s_cmp_lt_u32 s40, 4
    s_cbranch_scc1 L_k2_wo_kernel_loop
    s_nop 7
    s_nop 7
    s_waitcnt vmcnt(0)
    s_lshl_b32 s3, s27, 5
    v_add_u32 v4, s3, v2
    v_mul_u32_u24 v4, 272, v4
    v_lshl_add_u32 v4, v3, 4, v4
    s_lshl_b32 s3, s28, 7
    v_add_u32 v4, s3, v4
    s_barrier
    ds_write_b128 v4, v[32:35] offset:0
    ds_write_b128 v4, v[36:39] offset:64
    ds_write_b128 v4, v[40:43] offset:4352
    ds_write_b128 v4, v[44:47] offset:4416
    v_lshrrev_b32 v5, 3, v1
    s_lshl_b32 s3, s26, 4
    v_add_u32 v5, s3, v5
    v_mul_u32_u24 v5, 272, v5
    v_and_b32 v6, 7, v1
    v_lshl_add_u32 v5, v6, 5, v5
    s_waitcnt lgkmcnt(0)
    s_barrier
    ds_read_b128 v[48:51], v5 offset:0
    ds_read_b128 v[52:55], v5 offset:16
    ds_read_b128 v[56:59], v5 offset:2176
    ds_read_b128 v[60:63], v5 offset:2192
    s_waitcnt lgkmcnt(0)
    v_lshlrev_b32 v64, 16, v96
    v_and_b32 v65, 0xffff0000, v96
    v_lshlrev_b32 v66, 16, v97
    v_and_b32 v67, 0xffff0000, v97
    v_lshlrev_b32 v68, 16, v98
    v_and_b32 v69, 0xffff0000, v98
    v_lshlrev_b32 v70, 16, v99
    v_and_b32 v71, 0xffff0000, v99
    v_pk_add_f32 v[48:49], v[48:49], v[64:65]
    v_pk_add_f32 v[50:51], v[50:51], v[66:67]
    v_pk_add_f32 v[52:53], v[52:53], v[68:69]
    v_pk_add_f32 v[54:55], v[54:55], v[70:71]
    v_cvt_pk_bf16_f32 v96, v48, v49
    v_cvt_pk_bf16_f32 v97, v50, v51
    v_cvt_pk_bf16_f32 v98, v52, v53
    v_cvt_pk_bf16_f32 v99, v54, v55
    buffer_store_dwordx4 v[96:99], v10, s[36:39], 0 offen
    v_lshlrev_b32 v64, 16, v100
    v_and_b32 v65, 0xffff0000, v100
    v_lshlrev_b32 v66, 16, v101
    v_and_b32 v67, 0xffff0000, v101
    v_lshlrev_b32 v68, 16, v102
    v_and_b32 v69, 0xffff0000, v102
    v_lshlrev_b32 v70, 16, v103
    v_and_b32 v71, 0xffff0000, v103
    v_pk_add_f32 v[56:57], v[56:57], v[64:65]
    v_pk_add_f32 v[58:59], v[58:59], v[66:67]
    v_pk_add_f32 v[60:61], v[60:61], v[68:69]
    v_pk_add_f32 v[62:63], v[62:63], v[70:71]
    v_cvt_pk_bf16_f32 v100, v56, v57
    v_cvt_pk_bf16_f32 v101, v58, v59
    v_cvt_pk_bf16_f32 v102, v60, v61
    v_cvt_pk_bf16_f32 v103, v62, v63
    buffer_store_dwordx4 v[100:103], v11, s[36:39], 0 offen
L_k2_wo_kernel_done:
    s_endpgm
.globl k3_w1_kernel
.p2align 8
.type k3_w1_kernel,@function
k3_w1_kernel:
    s_cmp_ge_u32 s2, 256
    s_cbranch_scc1 L_k3_done
    s_load_dwordx16 s[64:79], s[0:1], 0
    s_load_dwordx4 s[80:83], s[0:1], 64
    s_load_dwordx2 s[84:85], s[0:1], 80
    v_and_b32 v1, 63, v0
    v_lshrrev_b32 v4, 6, v0
    v_and_b32 v2, 15, v0
    v_bfe_u32 v3, v0, 4, 2
    v_readfirstlane_b32 s26, v4
    s_waitcnt lgkmcnt(0)
    s_lshr_b32 s51, s26, 2
    s_and_b32 s26, s26, 3
    s_bfe_u32 s24, s2, 0x20001
    s_lshl_b32 s24, s24, 2
    s_lshr_b32 s25, s2, 6
    s_add_u32 s24, s24, s25
    s_and_b32 s25, s2, 1
    s_lshl_b32 s25, s25, 3
    s_bfe_u32 s3, s2, 0x30003
    s_add_u32 s25, s25, s3
    s_add_u32 s12, s84, 2097152
    s_addc_u32 s13, s85, 0
    s_and_b32 s13, s13, 0xffff
    s_mov_b32 s14, 2097152
    s_mov_b32 s15, 0x00020000
    s_mov_b32 s16, s72
    s_and_b32 s17, s73, 0xffff
    s_mov_b32 s18, 1835008
    s_mov_b32 s19, 0x00020000
    s_add_u32 s20, s84, 4194304
    s_addc_u32 s21, s85, 0
    s_and_b32 s21, s21, 0xffff
    s_mov_b32 s22, 7340032
    s_mov_b32 s23, 0x00020000
    s_mov_b32 s36, s74
    s_and_b32 s37, s75, 0xffff
    s_mov_b32 s38, 3584
    s_mov_b32 s39, 0x00020000
    s_lshl_b32 s27, s24, 7
    s_mul_i32 s30, s25, 224
    v_lshrrev_b32 v5, 3, v1
    v_and_b32 v6, 7, v1
    s_lshl_b32 s3, s26, 2
    v_lshrrev_b32 v7, 1, v5
    v_add_u32 v7, s3, v7
    v_and_b32 v7, 7, v7
    v_xor_b32 v6, v6, v7
    s_mul_i32 s3, s26, 8
    s_add_u32 s3, s3, s27
    v_add_u32 v5, s3, v5
    s_mov_b32 s3, 1024
    v_mul_lo_u32 v5, v5, s3
    v_lshl_add_u32 v8, v6, 4, v5
    s_lshl_b32 s3, s26, 6
    s_add_u32 s3, s3, 0
    v_add_u32 v13, s3, v1
    v_mul_u32_u24 v14, 2341, v13
    v_lshrrev_b32 v14, 15, v14
    v_mul_u32_u24 v15, 14, v14
    v_sub_u32 v15, v13, v15
    v_lshrrev_b32 v16, 1, v15
    v_and_b32 v15, 1, v15
    v_bfe_u32 v13, v14, 3, 1
    v_lshlrev_b32 v13, 2, v13
    v_sub_u32 v16, v16, v13
    v_add_u32 v16, 7, v16
    v_subrev_u32 v13, 7, v16
    v_min_u32 v16, v16, v13
    v_lshlrev_b32 v16, 5, v16
    v_lshl_add_u32 v16, v15, 4, v16
    v_mul_u32_u24 v14, 3584, v14
    v_add3_u32 v9, v14, v16, s30
    s_lshl_b32 s3, s26, 6
    s_add_u32 s3, s3, 256
    v_add_u32 v13, s3, v1
    v_mul_u32_u24 v14, 2341, v13
    v_lshrrev_b32 v14, 15, v14
    v_mul_u32_u24 v15, 14, v14
    v_sub_u32 v15, v13, v15
    v_lshrrev_b32 v16, 1, v15
    v_and_b32 v15, 1, v15
    v_bfe_u32 v13, v14, 3, 1
    v_lshlrev_b32 v13, 2, v13
    v_sub_u32 v16, v16, v13
    v_add_u32 v16, 7, v16
    v_subrev_u32 v13, 7, v16
    v_min_u32 v16, v16, v13
    v_lshlrev_b32 v16, 5, v16
    v_lshl_add_u32 v16, v15, 4, v16
    v_mul_u32_u24 v14, 3584, v14
    v_add3_u32 v10, v14, v16, s30
    s_lshl_b32 s3, s26, 6
    s_add_u32 s3, s3, 512
    v_add_u32 v13, s3, v1
    v_mul_u32_u24 v14, 2341, v13
    v_lshrrev_b32 v14, 15, v14
    v_mul_u32_u24 v15, 14, v14
    v_sub_u32 v15, v13, v15
    v_lshrrev_b32 v16, 1, v15
    v_and_b32 v15, 1, v15
    v_bfe_u32 v13, v14, 3, 1
    v_lshlrev_b32 v13, 2, v13
    v_sub_u32 v16, v16, v13
    v_add_u32 v16, 7, v16
    v_subrev_u32 v13, 7, v16
    v_min_u32 v16, v16, v13
    v_lshlrev_b32 v16, 5, v16
    v_lshl_add_u32 v16, v15, 4, v16
    v_mul_u32_u24 v14, 3584, v14
    v_add3_u32 v11, v14, v16, s30
    s_lshl_b32 s3, s26, 6
    s_add_u32 s3, s3, 768
    v_add_u32 v13, s3, v1
    v_mul_u32_u24 v14, 2341, v13
    v_lshrrev_b32 v14, 15, v14
    v_mul_u32_u24 v15, 14, v14
    v_sub_u32 v15, v13, v15
    v_lshrrev_b32 v16, 1, v15
    v_and_b32 v15, 1, v15
    v_bfe_u32 v13, v14, 3, 1
    v_lshlrev_b32 v13, 2, v13
    v_sub_u32 v16, v16, v13
    v_add_u32 v16, 7, v16
    v_subrev_u32 v13, 7, v16
    v_min_u32 v16, v16, v13
    v_lshlrev_b32 v16, 5, v16
    v_lshl_add_u32 v16, v15, 4, v16
    v_mul_u32_u24 v14, 3584, v14
    v_add3_u32 v12, v14, v16, s30
    s_mov_b32 s40, 0
    s_mov_b32 s41, 0
    s_mov_b32 s42, 0
    s_mov_b32 s43, 0
    s_mov_b32 s44, 0
    s_lshl_b32 s46, s26, 10
    s_cmp_eq_u32 s51, 0
    s_cbranch_scc1 L_k3_compute
L_k3_loader:
    s_add_u32 s47, s41, s46
    s_add_u32 m0, s47, 0
    s_add_u32 s48, s42, 0
    buffer_load_dwordx4 v8, s[12:15], s48 offen lds
    s_add_u32 m0, s47, 4096
    s_add_u32 s48, s42, 32768
    buffer_load_dwordx4 v8, s[12:15], s48 offen lds
    s_add_u32 m0, s47, 8192
    s_add_u32 s48, s42, 65536
    buffer_load_dwordx4 v8, s[12:15], s48 offen lds
    s_add_u32 m0, s47, 12288
    s_add_u32 s48, s42, 98304
    buffer_load_dwordx4 v8, s[12:15], s48 offen lds
    s_add_u32 m0, s47, 16384
    s_add_u32 s48, s43, 0
    buffer_load_dwordx4 v9, s[16:19], s48 offen lds
    s_add_u32 m0, s47, 20480
    s_add_u32 s48, s43, 0
    buffer_load_dwordx4 v10, s[16:19], s48 offen lds
    s_add_u32 m0, s47, 24576
    s_add_u32 s48, s43, 0
    buffer_load_dwordx4 v11, s[16:19], s48 offen lds
    s_add_u32 m0, s47, 28672
    s_add_u32 s48, s43, 0
    buffer_load_dwordx4 v12, s[16:19], s48 offen lds
    s_add_u32 s41, s41, 32768
    s_cmp_ge_u32 s41, 98304
    s_cselect_b32 s41, 0, s41
    s_add_u32 s42, s42, 128
    s_add_u32 s43, s43, 229376
    s_cmp_ge_u32 s42, 1024
    s_cselect_b32 s42, 0, s42
    s_cselect_b32 s43, 0, s43
    s_add_u32 s47, s41, s46
    s_add_u32 m0, s47, 0
    s_add_u32 s48, s42, 0
    buffer_load_dwordx4 v8, s[12:15], s48 offen lds
    s_add_u32 m0, s47, 4096
    s_add_u32 s48, s42, 32768
    buffer_load_dwordx4 v8, s[12:15], s48 offen lds
    s_add_u32 m0, s47, 8192
    s_add_u32 s48, s42, 65536
    buffer_load_dwordx4 v8, s[12:15], s48 offen lds
    s_add_u32 m0, s47, 12288
    s_add_u32 s48, s42, 98304
    buffer_load_dwordx4 v8, s[12:15], s48 offen lds
    s_add_u32 m0, s47, 16384
    s_add_u32 s48, s43, 0
    buffer_load_dwordx4 v9, s[16:19], s48 offen lds
    s_add_u32 m0, s47, 20480
    s_add_u32 s48, s43, 0
    buffer_load_dwordx4 v10, s[16:19], s48 offen lds
    s_add_u32 m0, s47, 24576
    s_add_u32 s48, s43, 0
    buffer_load_dwordx4 v11, s[16:19], s48 offen lds
    s_add_u32 m0, s47, 28672
    s_add_u32 s48, s43, 0
    buffer_load_dwordx4 v12, s[16:19], s48 offen lds
    s_add_u32 s41, s41, 32768
    s_cmp_ge_u32 s41, 98304
    s_cselect_b32 s41, 0, s41
    s_add_u32 s42, s42, 128
    s_add_u32 s43, s43, 229376
    s_cmp_ge_u32 s42, 1024
    s_cselect_b32 s42, 0, s42
    s_cselect_b32 s43, 0, s43
    s_waitcnt vmcnt(8)
    s_barrier
    s_add_u32 s47, s41, s46
    s_add_u32 m0, s47, 0
    s_add_u32 s48, s42, 0
    buffer_load_dwordx4 v8, s[12:15], s48 offen lds
    s_add_u32 m0, s47, 4096
    s_add_u32 s48, s42, 32768
    buffer_load_dwordx4 v8, s[12:15], s48 offen lds
    s_add_u32 m0, s47, 8192
    s_add_u32 s48, s42, 65536
    buffer_load_dwordx4 v8, s[12:15], s48 offen lds
    s_add_u32 m0, s47, 12288
    s_add_u32 s48, s42, 98304
    buffer_load_dwordx4 v8, s[12:15], s48 offen lds
    s_add_u32 m0, s47, 16384
    s_add_u32 s48, s43, 0
    buffer_load_dwordx4 v9, s[16:19], s48 offen lds
    s_add_u32 m0, s47, 20480
    s_add_u32 s48, s43, 0
    buffer_load_dwordx4 v10, s[16:19], s48 offen lds
    s_add_u32 m0, s47, 24576
    s_add_u32 s48, s43, 0
    buffer_load_dwordx4 v11, s[16:19], s48 offen lds
    s_add_u32 m0, s47, 28672
    s_add_u32 s48, s43, 0
    buffer_load_dwordx4 v12, s[16:19], s48 offen lds
    s_add_u32 s41, s41, 32768
    s_cmp_ge_u32 s41, 98304
    s_cselect_b32 s41, 0, s41
    s_add_u32 s42, s42, 128
    s_add_u32 s43, s43, 229376
    s_cmp_ge_u32 s42, 1024
    s_cselect_b32 s42, 0, s42
    s_cselect_b32 s43, 0, s43
L_k3_lloop:
    s_cmp_lt_u32 s40, 6
    s_cbranch_scc1 L_k3_wfull
    s_cmp_eq_u32 s40, 6
    s_cbranch_scc0 L_k3_w0
    s_waitcnt vmcnt(0)
    s_branch L_k3_wdone
L_k3_w0:
    s_waitcnt vmcnt(0)
    s_branch L_k3_wdone
L_k3_wfull:
    s_waitcnt vmcnt(8)
L_k3_wdone:
    s_barrier
    s_cmp_lt_u32 s40, 5
    s_cbranch_scc0 L_k3_noissue
    s_add_u32 s47, s41, s46
    s_add_u32 m0, s47, 0
    s_add_u32 s48, s42, 0
    buffer_load_dwordx4 v8, s[12:15], s48 offen lds
    s_add_u32 m0, s47, 4096
    s_add_u32 s48, s42, 32768
    buffer_load_dwordx4 v8, s[12:15], s48 offen lds
    s_add_u32 m0, s47, 8192
    s_add_u32 s48, s42, 65536
    buffer_load_dwordx4 v8, s[12:15], s48 offen lds
    s_add_u32 m0, s47, 12288
    s_add_u32 s48, s42, 98304
    buffer_load_dwordx4 v8, s[12:15], s48 offen lds
    s_add_u32 m0, s47, 16384
    s_add_u32 s48, s43, 0
    buffer_load_dwordx4 v9, s[16:19], s48 offen lds
    s_add_u32 m0, s47, 20480
    s_add_u32 s48, s43, 0
    buffer_load_dwordx4 v10, s[16:19], s48 offen lds
    s_add_u32 m0, s47, 24576
    s_add_u32 s48, s43, 0
    buffer_load_dwordx4 v11, s[16:19], s48 offen lds
    s_add_u32 m0, s47, 28672
    s_add_u32 s48, s43, 0
    buffer_load_dwordx4 v12, s[16:19], s48 offen lds
    s_add_u32 s41, s41, 32768
    s_cmp_ge_u32 s41, 98304
    s_cselect_b32 s41, 0, s41
    s_add_u32 s42, s42, 128
    s_add_u32 s43, s43, 229376
    s_cmp_ge_u32 s42, 1024
    s_cselect_b32 s42, 0, s42
    s_cselect_b32 s43, 0, s43
L_k3_noissue:
    s_add_u32 s40, s40, 1
    s_cmp_lt_u32 s40, 8
    s_cbranch_scc1 L_k3_lloop
    v_lshlrev_b32 v5, 3, v3
    v_add_u32 v5, s30, v5
    buffer_load_dwordx2 v[200:201], v5, s[36:39], 0 offen offset:0
    buffer_load_dwordx2 v[202:203], v5, s[36:39], 0 offen offset:32
    buffer_load_dwordx2 v[204:205], v5, s[36:39], 0 offen offset:64
    buffer_load_dwordx2 v[206:207], v5, s[36:39], 0 offen offset:96
    buffer_load_dwordx2 v[208:209], v5, s[36:39], 0 offen offset:128
    buffer_load_dwordx2 v[210:211], v5, s[36:39], 0 offen offset:160
    buffer_load_dwordx2 v[212:213], v5, s[36:39], 0 offen offset:192
    s_lshl_b32 s28, s26, 5
    s_add_u32 s28, s28, s27
    s_lshl_b32 s3, s26, 13
    s_add_u32 s3, s3, 32768
    v_lshlrev_b32 v9, 4, v1
    v_add_u32 v9, s3, v9
    s_barrier
    ds_read_b128 v[32:35], v9 offset:0
    ds_read_b128 v[36:39], v9 offset:1024
    ds_read_b128 v[40:43], v9 offset:2048
    ds_read_b128 v[44:47], v9 offset:3072
    ds_read_b128 v[48:51], v9 offset:4096
    ds_read_b128 v[52:55], v9 offset:5120
    ds_read_b128 v[56:59], v9 offset:6144
    ds_read_b128 v[216:219], v9 offset:7168
    s_waitcnt vmcnt(0) lgkmcnt(0)
    s_waitcnt vmcnt(0)
    s_branch L_k3_gelu
L_k3_compute:
    v_lshlrev_b32 v5, 3, v3
    v_add_u32 v5, s30, v5
    buffer_load_dwordx2 v[200:201], v5, s[36:39], 0 offen offset:0
    buffer_load_dwordx2 v[202:203], v5, s[36:39], 0 offen offset:32
    buffer_load_dwordx2 v[204:205], v5, s[36:39], 0 offen offset:64
    buffer_load_dwordx2 v[206:207], v5, s[36:39], 0 offen offset:96
    buffer_load_dwordx2 v[208:209], v5, s[36:39], 0 offen offset:128
    buffer_load_dwordx2 v[210:211], v5, s[36:39], 0 offen offset:160
    buffer_load_dwordx2 v[212:213], v5, s[36:39], 0 offen offset:192
    s_lshl_b32 s28, s26, 5
    s_add_u32 s28, s28, s27
    v_lshrrev_b32 v5, 1, v2
    v_mul_u32_u24 v6, 128, v2
    v_add_u32 v7, 0, v3
    v_xor_b32 v7, v7, v5
    v_lshl_add_u32 v13, v7, 4, v6
    v_add_u32 v7, 4, v3
    v_xor_b32 v7, v7, v5
    v_lshl_add_u32 v14, v7, 4, v6
    s_mul_i32 s3, s26, 4096
    v_add_u32 v13, s3, v13
    v_add_u32 v14, s3, v14
    v_lshrrev_b32 v5, 2, v2
    v_and_b32 v6, 3, v2
    v_lshl_add_u32 v5, v3, 3, v5
    v_mul_u32_u24 v5, 224, v5
    v_lshl_add_u32 v5, v6, 3, v5
    v_add_u32 v5, 16384, v5
    v_and_b32 v6, 1, v3
    v_lshl_add_u32 v15, v6, 7, v5
    v_mul_u32_u24 v7, 96, v6
    v_sub_u32 v16, v5, v7
    v_lshlrev_b32 v6, 2, v6
    v_add_u32 v7, s26, v6
    v_subrev_u32 v17, 7, v7
    v_min_u32 v7, v7, v17
    v_lshl_add_u32 v17, v7, 5, v5
    s_add_u32 s3, s26, 4
    s_min_u32 s3, s3, 6
    v_add_u32 v7, s3, v6
    v_subrev_u32 v18, 7, v7
    v_min_u32 v7, v7, v18
    v_lshl_add_u32 v18, v7, 5, v5
    v_mov_b32 v228, 0
    v_mov_b32 v229, 0
    v_mov_b32 v230, 0
    v_mov_b32 v231, 0
    v_mov_b32 v232, 0
    v_mov_b32 v233, 0
    v_mov_b32 v234, 0
    v_mov_b32 v235, 0
    v_mov_b32 v236, 0
    v_mov_b32 v237, 0
    v_mov_b32 v238, 0
    v_mov_b32 v239, 0
    v_mov_b32 v240, 0
    v_mov_b32 v241, 0
    v_mov_b32 v242, 0
    v_mov_b32 v243, 0
    v_mov_b32 v26, 0x3f803f80
    v_mov_b32 v188, 0x3f803f80
    v_mov_b32 v189, 0x3f803f80
    v_mov_b32 v190, 0x3f803f80
    v_mov_b32 v191, 0x3f803f80
    v_mov_b32 v32, 0
    v_mov_b32 v33, 0
    v_mov_b32 v34, 0
    v_mov_b32 v35, 0
    v_mov_b32 v36, 0
    v_mov_b32 v37, 0
    v_mov_b32 v38, 0
    v_mov_b32 v39, 0
    v_mov_b32 v40, 0
    v_mov_b32 v41, 0
    v_mov_b32 v42, 0
    v_mov_b32 v43, 0
    v_mov_b32 v44, 0
    v_mov_b32 v45, 0
    v_mov_b32 v46, 0
    v_mov_b32 v47, 0
    v_mov_b32 v48, 0
    v_mov_b32 v49, 0
    v_mov_b32 v50, 0
    v_mov_b32 v51, 0
    v_mov_b32 v52, 0
    v_mov_b32 v53, 0
    v_mov_b32 v54, 0
    v_mov_b32 v55, 0
    v_mov_b32 v56, 0
    v_mov_b32 v57, 0
    v_mov_b32 v58, 0
    v_mov_b32 v59, 0
    v_mov_b32 v60, 0
    v_mov_b32 v61, 0
    v_mov_b32 v62, 0
    v_mov_b32 v63, 0
    v_mov_b32 v64, 0
    v_mov_b32 v65, 0
    v_mov_b32 v66, 0
    v_mov_b32 v67, 0
    v_mov_b32 v68, 0
    v_mov_b32 v69, 0
    v_mov_b32 v70, 0
    v_mov_b32 v71, 0
    v_mov_b32 v72, 0
    v_mov_b32 v73, 0
    v_mov_b32 v74, 0
    v_mov_b32 v75, 0
    v_mov_b32 v76, 0
    v_mov_b32 v77, 0
    v_mov_b32 v78, 0
    v_mov_b32 v79, 0
    v_mov_b32 v80, 0
    v_mov_b32 v81, 0
    v_mov_b32 v82, 0
    v_mov_b32 v83, 0
    v_mov_b32 v84, 0
    v_mov_b32 v85, 0
    v_mov_b32 v86, 0
    v_mov_b32 v87, 0
    v_mov_b32 v88, 0
    v_mov_b32 v89, 0
    v_mov_b32 v90, 0
    v_mov_b32 v91, 0
    v_mov_b32 v92, 0
    v_mov_b32 v93, 0
    v_mov_b32 v94, 0
    v_mov_b32 v95, 0
    v_mov_b32 v184, 0
    v_mov_b32 v185, 0
    v_mov_b32 v186, 0
    v_mov_b32 v187, 0
    v_mov_b32 v20, v13
    v_mov_b32 v21, v14
    v_mov_b32 v22, v15
    v_mov_b32 v23, v16
    v_mov_b32 v24, v17
    v_mov_b32 v25, v18
    s_barrier
    ds_read_b128 v[168:171], v20 offset:0
    ds_read_b128 v[172:175], v20 offset:2048
    ds_read_b64_tr_b16 v[96:97], v22 offset:0
    ds_read_b64_tr_b16 v[98:99], v22 offset:896
    ds_read_b64_tr_b16 v[100:101], v22 offset:32
    ds_read_b64_tr_b16 v[102:103], v22 offset:928
    ds_read_b64_tr_b16 v[104:105], v22 offset:64
    ds_read_b64_tr_b16 v[106:107], v22 offset:960
    ds_read_b64_tr_b16 v[108:109], v23 offset:96
    ds_read_b64_tr_b16 v[110:111], v23 offset:992
    ds_read_b64_tr_b16 v[112:113], v23 offset:128
    ds_read_b64_tr_b16 v[114:115], v23 offset:1024
    ds_read_b64_tr_b16 v[116:117], v23 offset:160
    ds_read_b64_tr_b16 v[118:119], v23 offset:1056
    ds_read_b64_tr_b16 v[120:121], v23 offset:192
    ds_read_b64_tr_b16 v[122:123], v23 offset:1088
    ds_read_b64_tr_b16 v[124:125], v24 offset:0
    ds_read_b64_tr_b16 v[126:127], v24 offset:896
    ds_read_b64_tr_b16 v[128:129], v25 offset:0
    ds_read_b64_tr_b16 v[130:131], v25 offset:896
    s_waitcnt lgkmcnt(0)
L_k3_loop:
    v_mfma_f32_16x16x32_bf16 v[32:35], v[96:99], v[168:171], v[32:35]
    ds_read_b128 v[176:179], v21 offset:0
    v_mfma_f32_16x16x32_bf16 v[60:63], v[96:99], v[172:175], v[60:63]
    ds_read_b128 v[180:183], v21 offset:2048
    v_mfma_f32_16x16x32_bf16 v[36:39], v[100:103], v[168:171], v[36:39]
    ds_read_b64_tr_b16 v[132:133], v22 offset:7168
    v_mfma_f32_16x16x32_bf16 v[64:67], v[100:103], v[172:175], v[64:67]
    ds_read_b64_tr_b16 v[134:135], v22 offset:8064
    v_mfma_f32_16x16x32_bf16 v[40:43], v[104:107], v[168:171], v[40:43]
    ds_read_b64_tr_b16 v[136:137], v22 offset:7200
    v_mfma_f32_16x16x32_bf16 v[68:71], v[104:107], v[172:175], v[68:71]
    ds_read_b64_tr_b16 v[138:139], v22 offset:8096
    v_mfma_f32_16x16x32_bf16 v[44:47], v[108:111], v[168:171], v[44:47]
    ds_read_b64_tr_b16 v[140:141], v22 offset:7232
    v_mfma_f32_16x16x32_bf16 v[72:75], v[108:111], v[172:175], v[72:75]
    ds_read_b64_tr_b16 v[142:143], v22 offset:8128
    v_mfma_f32_16x16x32_bf16 v[48:51], v[112:115], v[168:171], v[48:51]
    ds_read_b64_tr_b16 v[144:145], v23 offset:7264
    v_mfma_f32_16x16x32_bf16 v[76:79], v[112:115], v[172:175], v[76:79]
    ds_read_b64_tr_b16 v[146:147], v23 offset:8160
    v_mfma_f32_16x16x32_bf16 v[52:55], v[116:119], v[168:171], v[52:55]
    ds_read_b64_tr_b16 v[148:149], v23 offset:7296
    v_mfma_f32_16x16x32_bf16 v[80:83], v[116:119], v[172:175], v[80:83]
    ds_read_b64_tr_b16 v[150:151], v23 offset:8192
    v_mfma_f32_16x16x32_bf16 v[56:59], v[120:123], v[168:171], v[56:59]
    ds_read_b64_tr_b16 v[152:153], v23 offset:7328
    v_mfma_f32_16x16x32_bf16 v[84:87], v[120:123], v[172:175], v[84:87]
    ds_read_b64_tr_b16 v[154:155], v23 offset:8224
    v_mfma_f32_16x16x32_bf16 v[88:91], v[124:127], v[188:191], v[88:91]
    ds_read_b64_tr_b16 v[156:157], v23 offset:7360
    v_mfma_f32_16x16x32_bf16 v[92:95], v[128:131], v[188:191], v[92:95]
    ds_read_b64_tr_b16 v[158:159], v23 offset:8256
    v_mfma_f32_16x16x32_bf16 v[228:231], v[188:191], v[168:171], v[228:231]
    ds_read_b64_tr_b16 v[160:161], v24 offset:7168
    v_mfma_f32_16x16x32_bf16 v[232:235], v[168:171], v[168:171], v[232:235]
    ds_read_b64_tr_b16 v[162:163], v24 offset:8064
    v_mfma_f32_16x16x32_bf16 v[236:239], v[188:191], v[172:175], v[236:239]
    ds_read_b64_tr_b16 v[164:165], v25 offset:7168
    v_mfma_f32_16x16x32_bf16 v[240:243], v[172:175], v[172:175], v[240:243]
    ds_read_b64_tr_b16 v[166:167], v25 offset:8064
    s_waitcnt lgkmcnt(0)
    s_barrier
    s_add_u32 s44, s44, 32768
    s_cmp_ge_u32 s44, 98304
    s_cselect_b32 s44, 0, s44
    v_add_u32 v20, s44, v13
    v_add_u32 v21, s44, v14
    v_add_u32 v22, s44, v15
    v_add_u32 v23, s44, v16
    v_add_u32 v24, s44, v17
    v_add_u32 v25, s44, v18
    v_mfma_f32_16x16x32_bf16 v[32:35], v[132:135], v[176:179], v[32:35]
    ds_read_b128 v[168:171], v20 offset:0
    v_mfma_f32_16x16x32_bf16 v[60:63], v[132:135], v[180:183], v[60:63]
    ds_read_b128 v[172:175], v20 offset:2048
    v_mfma_f32_16x16x32_bf16 v[36:39], v[136:139], v[176:179], v[36:39]
    ds_read_b64_tr_b16 v[96:97], v22 offset:0
    v_mfma_f32_16x16x32_bf16 v[64:67], v[136:139], v[180:183], v[64:67]
    ds_read_b64_tr_b16 v[98:99], v22 offset:896
    v_mfma_f32_16x16x32_bf16 v[40:43], v[140:143], v[176:179], v[40:43]
    ds_read_b64_tr_b16 v[100:101], v22 offset:32
    v_mfma_f32_16x16x32_bf16 v[68:71], v[140:143], v[180:183], v[68:71]
    ds_read_b64_tr_b16 v[102:103], v22 offset:928
    v_mfma_f32_16x16x32_bf16 v[44:47], v[144:147], v[176:179], v[44:47]
    ds_read_b64_tr_b16 v[104:105], v22 offset:64
    v_mfma_f32_16x16x32_bf16 v[72:75], v[144:147], v[180:183], v[72:75]
    ds_read_b64_tr_b16 v[106:107], v22 offset:960
    v_mfma_f32_16x16x32_bf16 v[48:51], v[148:151], v[176:179], v[48:51]
    ds_read_b64_tr_b16 v[108:109], v23 offset:96
    v_mfma_f32_16x16x32_bf16 v[76:79], v[148:151], v[180:183], v[76:79]
    ds_read_b64_tr_b16 v[110:111], v23 offset:992
    v_mfma_f32_16x16x32_bf16 v[52:55], v[152:155], v[176:179], v[52:55]
    ds_read_b64_tr_b16 v[112:113], v23 offset:128
    v_mfma_f32_16x16x32_bf16 v[80:83], v[152:155], v[180:183], v[80:83]
    ds_read_b64_tr_b16 v[114:115], v23 offset:1024
    v_mfma_f32_16x16x32_bf16 v[56:59], v[156:159], v[176:179], v[56:59]
    ds_read_b64_tr_b16 v[116:117], v23 offset:160
    v_mfma_f32_16x16x32_bf16 v[84:87], v[156:159], v[180:183], v[84:87]
    ds_read_b64_tr_b16 v[118:119], v23 offset:1056
    v_mfma_f32_16x16x32_bf16 v[88:91], v[160:163], v[188:191], v[88:91]
    ds_read_b64_tr_b16 v[120:121], v23 offset:192
    v_mfma_f32_16x16x32_bf16 v[92:95], v[164:167], v[188:191], v[92:95]
    ds_read_b64_tr_b16 v[122:123], v23 offset:1088
    v_mfma_f32_16x16x32_bf16 v[228:231], v[188:191], v[176:179], v[228:231]
    ds_read_b64_tr_b16 v[124:125], v24 offset:0
    v_mfma_f32_16x16x32_bf16 v[232:235], v[176:179], v[176:179], v[232:235]
    ds_read_b64_tr_b16 v[126:127], v24 offset:896
    v_mfma_f32_16x16x32_bf16 v[236:239], v[188:191], v[180:183], v[236:239]
    ds_read_b64_tr_b16 v[128:129], v25 offset:0
    v_mfma_f32_16x16x32_bf16 v[240:243], v[180:183], v[180:183], v[240:243]
    ds_read_b64_tr_b16 v[130:131], v25 offset:896
    s_waitcnt lgkmcnt(0)
    s_add_u32 s40, s40, 1
    s_cmp_lt_u32 s40, 8
    s_cbranch_scc1 L_k3_loop
    s_nop 7
    s_nop 7
    s_waitcnt vmcnt(0)
    v_and_b32 v4, 3, v2
    v_cmp_eq_u32 s[36:37], 1, v4
    v_cmp_eq_u32 s[38:39], 2, v4
    v_cmp_eq_u32 vcc, 3, v4
    v_lshrrev_b32 v4, 2, v2
    v_lshl_add_u32 v4, v4, 4, v2
    v_lshlrev_b32 v4, 2, v4
    v_cndmask_b32 v232, v232, v233, s[36:37]
    v_cndmask_b32 v232, v232, v234, s[38:39]
    v_cndmask_b32 v232, v232, v235, vcc
    ds_bpermute_b32 v185, v4, v232
    v_mov_b32 v184, v228
    v_cndmask_b32 v240, v240, v241, s[36:37]
    v_cndmask_b32 v240, v240, v242, s[38:39]
    v_cndmask_b32 v240, v240, v243, vcc
    ds_bpermute_b32 v187, v4, v240
    v_mov_b32 v186, v236
    s_waitcnt lgkmcnt(0)
    v_mov_b32 v4, 0x3b000000
    v_mov_b32 v5, 0x3727c5ac
    v_mul_f32 v184, v184, v4
    v_mul_f32 v185, v185, v4
    v_fma_f32 v185, -v184, v184, v185
    v_max_f32 v185, 0, v185
    v_add_f32 v6, v185, v5
    v_rcp_f32 v7, v6
    v_rsq_f32 v6, v6
    s_nop 0
    v_fma_f32 v7, v185, v7, v5
    v_rsq_f32 v7, v7
    s_nop 0
    v_mul_f32 v218, v6, v7
    v_mul_f32 v219, v6, v7
    v_mul_f32 v216, v184, v218
    v_mul_f32 v217, v184, v218
    v_mul_f32 v186, v186, v4
    v_mul_f32 v187, v187, v4
    v_fma_f32 v187, -v186, v186, v187
    v_max_f32 v187, 0, v187
    v_add_f32 v6, v187, v5
    v_rcp_f32 v7, v6
    v_rsq_f32 v6, v6
    s_nop 0
    v_fma_f32 v7, v187, v7, v5
    v_rsq_f32 v7, v7
    s_nop 0
    v_mul_f32 v222, v6, v7
    v_mul_f32 v223, v6, v7
    v_mul_f32 v220, v186, v222
    v_mul_f32 v221, v186, v222
    v_lshlrev_b32 v6, 4, v3
    v_add_u32 v6, 131072, v6
    s_lshl_b32 s3, s26, 6
    v_add_u32 v7, s3, v6
    s_add_u32 s3, s26, 4
    s_min_u32 s3, s3, 6
    s_lshl_b32 s3, s3, 6
    v_add_u32 v8, s3, v6
    s_lshl_b32 s3, s26, 13
    s_add_u32 s3, s3, 32768
    v_lshlrev_b32 v9, 4, v1
    v_add_u32 v9, s3, v9
    ds_write_b128 v9, v[60:63] offset:0
    ds_write_b128 v9, v[64:67] offset:1024
    ds_write_b128 v9, v[68:71] offset:2048
    ds_write_b128 v9, v[72:75] offset:3072
    ds_write_b128 v9, v[76:79] offset:4096
    ds_write_b128 v9, v[80:83] offset:5120
    ds_write_b128 v9, v[84:87] offset:6144
    ds_write_b128 v9, v[220:223] offset:7168
    v_cmp_eq_u32 vcc, 0, v2
    s_and_saveexec_b64 s[34:35], vcc
    ds_write_b128 v7, v[88:91]
    ds_write_b128 v8, v[92:95]
    s_mov_b64 exec, s[34:35]
    s_waitcnt lgkmcnt(0)
    s_barrier
L_k3_gelu:
    v_lshlrev_b32 v6, 4, v3
    v_add_u32 v6, 131072, v6
    ds_read_b128 v[96:99], v6 offset:0
    ds_read_b128 v[100:103], v6 offset:64
    ds_read_b128 v[104:107], v6 offset:128
    ds_read_b128 v[108:111], v6 offset:192
    ds_read_b128 v[112:115], v6 offset:256
    ds_read_b128 v[116:119], v6 offset:320
    ds_read_b128 v[120:123], v6 offset:384
    s_lshl_b32 s31, s26, 1
    s_add_u32 s31, s31, s51
    s_mul_i32 s31, s31, 3840
    s_lshl_b32 s3, s51, 4
    s_add_u32 s28, s28, s3
    s_mov_b32 s32, 3584
    v_mul_u32_u24 v30, 240, v2
    v_lshl_add_u32 v30, v3, 3, v30
    v_add_u32 v30, s31, v30
    v_mov_b32 v224, 0xc0135761
    v_mov_b32 v225, 0xc0135761
    v_mov_b32 v226, 0xbdd2d3e8
    v_mov_b32 v227, 0xbdd2d3e8
    v_lshlrev_b32 v124, 16, v200
    v_and_b32 v125, 0xffff0000, v200
    v_lshlrev_b32 v126, 16, v201
    v_and_b32 v127, 0xffff0000, v201
    v_lshlrev_b32 v128, 16, v202
    v_and_b32 v129, 0xffff0000, v202
    v_lshlrev_b32 v130, 16, v203
    v_and_b32 v131, 0xffff0000, v203
    v_lshlrev_b32 v132, 16, v204
    v_and_b32 v133, 0xffff0000, v204
    v_lshlrev_b32 v134, 16, v205
    v_and_b32 v135, 0xffff0000, v205
    v_lshlrev_b32 v136, 16, v206
    v_and_b32 v137, 0xffff0000, v206
    v_lshlrev_b32 v138, 16, v207
    v_and_b32 v139, 0xffff0000, v207
    v_lshlrev_b32 v140, 16, v208
    v_and_b32 v141, 0xffff0000, v208
    v_lshlrev_b32 v142, 16, v209
    v_and_b32 v143, 0xffff0000, v209
    v_lshlrev_b32 v144, 16, v210
    v_and_b32 v145, 0xffff0000, v210
    v_lshlrev_b32 v146, 16, v211
    v_and_b32 v147, 0xffff0000, v211
    v_lshlrev_b32 v148, 16, v212
    v_and_b32 v149, 0xffff0000, v212
    v_lshlrev_b32 v150, 16, v213
    v_and_b32 v151, 0xffff0000, v213
    s_waitcnt lgkmcnt(0)
    v_pk_fma_f32 v[152:153], v[216:217], v[96:97], v[124:125] neg_lo:[1,0,0] neg_hi:[1,0,0]
    v_pk_fma_f32 v[154:155], v[216:217], v[98:99], v[126:127] neg_lo:[1,0,0] neg_hi:[1,0,0]
    v_pk_fma_f32 v[156:157], v[216:217], v[100:101], v[128:129] neg_lo:[1,0,0] neg_hi:[1,0,0]
    v_pk_fma_f32 v[158:159], v[216:217], v[102:103], v[130:131] neg_lo:[1,0,0] neg_hi:[1,0,0]
    v_pk_fma_f32 v[160:161], v[216:217], v[104:105], v[132:133] neg_lo:[1,0,0] neg_hi:[1,0,0]
    v_pk_fma_f32 v[162:163], v[216:217], v[106:107], v[134:135] neg_lo:[1,0,0] neg_hi:[1,0,0]
    v_pk_fma_f32 v[164:165], v[216:217], v[108:109], v[136:137] neg_lo:[1,0,0] neg_hi:[1,0,0]
    v_pk_fma_f32 v[166:167], v[216:217], v[110:111], v[138:139] neg_lo:[1,0,0] neg_hi:[1,0,0]
    v_pk_fma_f32 v[168:169], v[216:217], v[112:113], v[140:141] neg_lo:[1,0,0] neg_hi:[1,0,0]
    v_pk_fma_f32 v[170:171], v[216:217], v[114:115], v[142:143] neg_lo:[1,0,0] neg_hi:[1,0,0]
    v_pk_fma_f32 v[172:173], v[216:217], v[116:117], v[144:145] neg_lo:[1,0,0] neg_hi:[1,0,0]
    v_pk_fma_f32 v[174:175], v[216:217], v[118:119], v[146:147] neg_lo:[1,0,0] neg_hi:[1,0,0]
    v_pk_fma_f32 v[176:177], v[216:217], v[120:121], v[148:149] neg_lo:[1,0,0] neg_hi:[1,0,0]
    v_pk_fma_f32 v[178:179], v[216:217], v[122:123], v[150:151] neg_lo:[1,0,0] neg_hi:[1,0,0]
    v_pk_fma_f32 v[32:33], v[32:33], v[218:219], v[152:153]
    v_pk_fma_f32 v[34:35], v[34:35], v[218:219], v[154:155]
    v_pk_fma_f32 v[36:37], v[36:37], v[218:219], v[156:157]
    v_pk_fma_f32 v[38:39], v[38:39], v[218:219], v[158:159]
    v_pk_fma_f32 v[40:41], v[40:41], v[218:219], v[160:161]
    v_pk_fma_f32 v[42:43], v[42:43], v[218:219], v[162:163]
    v_pk_fma_f32 v[44:45], v[44:45], v[218:219], v[164:165]
    v_pk_fma_f32 v[46:47], v[46:47], v[218:219], v[166:167]
    v_pk_fma_f32 v[48:49], v[48:49], v[218:219], v[168:169]
    v_pk_fma_f32 v[50:51], v[50:51], v[218:219], v[170:171]
    v_pk_fma_f32 v[52:53], v[52:53], v[218:219], v[172:173]
    v_pk_fma_f32 v[54:55], v[54:55], v[218:219], v[174:175]
    v_pk_fma_f32 v[56:57], v[56:57], v[218:219], v[176:177]
    v_pk_fma_f32 v[58:59], v[58:59], v[218:219], v[178:179]
    v_pk_mul_f32 v[152:153], v[32:33], v[32:33]
    v_pk_mul_f32 v[154:155], v[34:35], v[34:35]
    v_pk_mul_f32 v[156:157], v[36:37], v[36:37]
    v_pk_mul_f32 v[158:159], v[38:39], v[38:39]
    v_pk_mul_f32 v[160:161], v[40:41], v[40:41]
    v_pk_mul_f32 v[162:163], v[42:43], v[42:43]
    v_pk_mul_f32 v[164:165], v[44:45], v[44:45]
    v_pk_mul_f32 v[166:167], v[46:47], v[46:47]
    v_pk_mul_f32 v[168:169], v[48:49], v[48:49]
    v_pk_mul_f32 v[170:171], v[50:51], v[50:51]
    v_pk_mul_f32 v[172:173], v[52:53], v[52:53]
    v_pk_mul_f32 v[174:175], v[54:55], v[54:55]
    v_pk_mul_f32 v[176:177], v[56:57], v[56:57]
    v_pk_mul_f32 v[178:179], v[58:59], v[58:59]
    v_pk_fma_f32 v[152:153], v[152:153], v[226:227], v[224:225]
    v_pk_fma_f32 v[154:155], v[154:155], v[226:227], v[224:225]
    v_pk_fma_f32 v[156:157], v[156:157], v[226:227], v[224:225]
    v_pk_fma_f32 v[158:159], v[158:159], v[226:227], v[224:225]
    v_pk_fma_f32 v[160:161], v[160:161], v[226:227], v[224:225]
    v_pk_fma_f32 v[162:163], v[162:163], v[226:227], v[224:225]
    v_pk_fma_f32 v[164:165], v[164:165], v[226:227], v[224:225]
    v_pk_fma_f32 v[166:167], v[166:167], v[226:227], v[224:225]
    v_pk_fma_f32 v[168:169], v[168:169], v[226:227], v[224:225]
    v_pk_fma_f32 v[170:171], v[170:171], v[226:227], v[224:225]
    v_pk_fma_f32 v[172:173], v[172:173], v[226:227], v[224:225]
    v_pk_fma_f32 v[174:175], v[174:175], v[226:227], v[224:225]
    v_pk_fma_f32 v[176:177], v[176:177], v[226:227], v[224:225]
    v_pk_fma_f32 v[178:179], v[178:179], v[226:227], v[224:225]
    v_pk_mul_f32 v[152:153], v[152:153], v[32:33]
    v_pk_mul_f32 v[154:155], v[154:155], v[34:35]
    v_pk_mul_f32 v[156:157], v[156:157], v[36:37]
    v_pk_mul_f32 v[158:159], v[158:159], v[38:39]
    v_pk_mul_f32 v[160:161], v[160:161], v[40:41]
    v_pk_mul_f32 v[162:163], v[162:163], v[42:43]
    v_pk_mul_f32 v[164:165], v[164:165], v[44:45]
    v_pk_mul_f32 v[166:167], v[166:167], v[46:47]
    v_pk_mul_f32 v[168:169], v[168:169], v[48:49]
    v_pk_mul_f32 v[170:171], v[170:171], v[50:51]
    v_pk_mul_f32 v[172:173], v[172:173], v[52:53]
    v_pk_mul_f32 v[174:175], v[174:175], v[54:55]
    v_pk_mul_f32 v[176:177], v[176:177], v[56:57]
    v_pk_mul_f32 v[178:179], v[178:179], v[58:59]
    v_exp_f32 v152, v152
    v_exp_f32 v153, v153
    v_exp_f32 v154, v154
    v_exp_f32 v155, v155
    v_exp_f32 v156, v156
    v_exp_f32 v157, v157
    v_exp_f32 v158, v158
    v_exp_f32 v159, v159
    v_exp_f32 v160, v160
    v_exp_f32 v161, v161
    v_exp_f32 v162, v162
    v_exp_f32 v163, v163
    v_exp_f32 v164, v164
    v_exp_f32 v165, v165
    v_exp_f32 v166, v166
    v_exp_f32 v167, v167
    v_exp_f32 v168, v168
    v_exp_f32 v169, v169
    v_exp_f32 v170, v170
    v_exp_f32 v171, v171
    v_exp_f32 v172, v172
    v_exp_f32 v173, v173
    v_exp_f32 v174, v174
    v_exp_f32 v175, v175
    v_exp_f32 v176, v176
    v_exp_f32 v177, v177
    v_exp_f32 v178, v178
    v_exp_f32 v179, v179
    v_pk_add_f32 v[152:153], v[152:153], 1.0 op_sel_hi:[1,0]
    v_pk_add_f32 v[154:155], v[154:155], 1.0 op_sel_hi:[1,0]
    v_pk_add_f32 v[156:157], v[156:157], 1.0 op_sel_hi:[1,0]
    v_pk_add_f32 v[158:159], v[158:159], 1.0 op_sel_hi:[1,0]
    v_pk_add_f32 v[160:161], v[160:161], 1.0 op_sel_hi:[1,0]
    v_pk_add_f32 v[162:163], v[162:163], 1.0 op_sel_hi:[1,0]
    v_pk_add_f32 v[164:165], v[164:165], 1.0 op_sel_hi:[1,0]
    v_pk_add_f32 v[166:167], v[166:167], 1.0 op_sel_hi:[1,0]
    v_pk_add_f32 v[168:169], v[168:169], 1.0 op_sel_hi:[1,0]
    v_pk_add_f32 v[170:171], v[170:171], 1.0 op_sel_hi:[1,0]
    v_pk_add_f32 v[172:173], v[172:173], 1.0 op_sel_hi:[1,0]
    v_pk_add_f32 v[174:175], v[174:175], 1.0 op_sel_hi:[1,0]
    v_pk_add_f32 v[176:177], v[176:177], 1.0 op_sel_hi:[1,0]
    v_pk_add_f32 v[178:179], v[178:179], 1.0 op_sel_hi:[1,0]
    v_rcp_f32 v152, v152
    v_rcp_f32 v153, v153
    v_rcp_f32 v154, v154
    v_rcp_f32 v155, v155
    v_rcp_f32 v156, v156
    v_rcp_f32 v157, v157
    v_rcp_f32 v158, v158
    v_rcp_f32 v159, v159
    v_rcp_f32 v160, v160
    v_rcp_f32 v161, v161
    v_rcp_f32 v162, v162
    v_rcp_f32 v163, v163
    v_rcp_f32 v164, v164
    v_rcp_f32 v165, v165
    v_rcp_f32 v166, v166
    v_rcp_f32 v167, v167
    v_rcp_f32 v168, v168
    v_rcp_f32 v169, v169
    v_rcp_f32 v170, v170
    v_rcp_f32 v171, v171
    v_rcp_f32 v172, v172
    v_rcp_f32 v173, v173
    v_rcp_f32 v174, v174
    v_rcp_f32 v175, v175
    v_rcp_f32 v176, v176
    v_rcp_f32 v177, v177
    v_rcp_f32 v178, v178
    v_rcp_f32 v179, v179
    v_pk_mul_f32 v[32:33], v[32:33], v[152:153]
    v_pk_mul_f32 v[34:35], v[34:35], v[154:155]
    v_pk_mul_f32 v[36:37], v[36:37], v[156:157]
    v_pk_mul_f32 v[38:39], v[38:39], v[158:159]
    v_pk_mul_f32 v[40:41], v[40:41], v[160:161]
    v_pk_mul_f32 v[42:43], v[42:43], v[162:163]
    v_pk_mul_f32 v[44:45], v[44:45], v[164:165]
    v_pk_mul_f32 v[46:47], v[46:47], v[166:167]
    v_pk_mul_f32 v[48:49], v[48:49], v[168:169]
    v_pk_mul_f32 v[50:51], v[50:51], v[170:171]
    v_pk_mul_f32 v[52:53], v[52:53], v[172:173]
    v_pk_mul_f32 v[54:55], v[54:55], v[174:175]
    v_pk_mul_f32 v[56:57], v[56:57], v[176:177]
    v_pk_mul_f32 v[58:59], v[58:59], v[178:179]
    v_cvt_pk_bf16_f32 v152, v32, v33
    v_cvt_pk_bf16_f32 v153, v34, v35
    v_cvt_pk_bf16_f32 v156, v36, v37
    v_cvt_pk_bf16_f32 v157, v38, v39
    v_cvt_pk_bf16_f32 v160, v40, v41
    v_cvt_pk_bf16_f32 v161, v42, v43
    v_cvt_pk_bf16_f32 v164, v44, v45
    v_cvt_pk_bf16_f32 v165, v46, v47
    v_cvt_pk_bf16_f32 v168, v48, v49
    v_cvt_pk_bf16_f32 v169, v50, v51
    v_cvt_pk_bf16_f32 v172, v52, v53
    v_cvt_pk_bf16_f32 v173, v54, v55
    v_cvt_pk_bf16_f32 v176, v56, v57
    v_cvt_pk_bf16_f32 v177, v58, v59
    ds_write_b64 v30, v[152:153] offset:0
    ds_write_b64 v30, v[156:157] offset:32
    ds_write_b64 v30, v[160:161] offset:64
    ds_write_b64 v30, v[164:165] offset:96
    ds_write_b64 v30, v[168:169] offset:128
    ds_write_b64 v30, v[172:173] offset:160
    ds_write_b64 v30, v[176:177] offset:192
    v_add_u32 v4, 0, v1
    v_mul_u32_u24 v5, 2341, v4
    v_lshrrev_b32 v5, 15, v5
    v_mul_u32_u24 v6, 14, v5
    v_sub_u32 v6, v4, v6
    v_lshlrev_b32 v6, 4, v6
    v_mul_u32_u24 v7, 240, v5
    v_add3_u32 v32, v7, v6, s31
    v_add_u32 v5, s28, v5
    v_mul_lo_u32 v5, v5, s32
    v_add3_u32 v40, v5, v6, s30
    v_add_u32 v4, 64, v1
    v_mul_u32_u24 v5, 2341, v4
    v_lshrrev_b32 v5, 15, v5
    v_mul_u32_u24 v6, 14, v5
    v_sub_u32 v6, v4, v6
    v_lshlrev_b32 v6, 4, v6
    v_mul_u32_u24 v7, 240, v5
    v_add3_u32 v33, v7, v6, s31
    v_add_u32 v5, s28, v5
    v_mul_lo_u32 v5, v5, s32
    v_add3_u32 v41, v5, v6, s30
    v_add_u32 v4, 128, v1
    v_mul_u32_u24 v5, 2341, v4
    v_lshrrev_b32 v5, 15, v5
    v_mul_u32_u24 v6, 14, v5
    v_sub_u32 v6, v4, v6
    v_lshlrev_b32 v6, 4, v6
    v_mul_u32_u24 v7, 240, v5
    v_add3_u32 v34, v7, v6, s31
    v_add_u32 v5, s28, v5
    v_mul_lo_u32 v5, v5, s32
    v_add3_u32 v42, v5, v6, s30
    v_add_u32 v4, 192, v1
    v_mul_u32_u24 v5, 2341, v4
    v_lshrrev_b32 v5, 15, v5
    v_mul_u32_u24 v6, 14, v5
    v_sub_u32 v6, v4, v6
    v_lshlrev_b32 v6, 4, v6
    v_mul_u32_u24 v7, 240, v5
    v_add3_u32 v35, v7, v6, s31
    v_add_u32 v5, s28, v5
    v_mul_lo_u32 v5, v5, s32
    v_add3_u32 v43, v5, v6, s30
    s_waitcnt lgkmcnt(0)
    ds_read_b128 v[96:99], v32
    ds_read_b128 v[100:103], v33
    ds_read_b128 v[104:107], v34
    ds_read_b128 v[108:111], v35
    s_waitcnt lgkmcnt(3)
    buffer_store_dwordx4 v[96:99], v40, s[20:23], 0 offen
    s_waitcnt lgkmcnt(2)
    buffer_store_dwordx4 v[100:103], v41, s[20:23], 0 offen
    s_waitcnt lgkmcnt(1)
    buffer_store_dwordx4 v[104:107], v42, s[20:23], 0 offen
    v_cmp_gt_u32 vcc, 32, v1
    s_and_saveexec_b64 s[34:35], vcc
    s_waitcnt lgkmcnt(0)
    buffer_store_dwordx4 v[108:111], v43, s[20:23], 0 offen
    s_mov_b64 exec, s[34:35]
L_k3_done:
    s_endpgm
.globl k4_w2_kernel
.p2align 8
.type k4_w2_kernel,@function
k4_w2_kernel:
    s_cmp_ge_u32 s2, 256
    s_cbranch_scc1 L_k4_w2_kernel_done
    s_load_dwordx16 s[64:79], s[0:1], 0
    s_load_dwordx4 s[80:83], s[0:1], 64
    s_load_dwordx2 s[84:85], s[0:1], 80
    v_and_b32 v1, 63, v0
    v_lshrrev_b32 v4, 6, v0
    v_and_b32 v2, 15, v0
    v_bfe_u32 v3, v0, 4, 2
    v_readfirstlane_b32 s26, v4
    s_waitcnt lgkmcnt(0)
    s_lshr_b32 s51, s26, 2
    s_and_b32 s26, s26, 3
    s_and_b32 s24, s2, 7
    s_lshl_b32 s24, s24, 2
    s_lshr_b32 s25, s2, 6
    s_add_u32 s24, s24, s25
    s_bfe_u32 s25, s2, 0x30003
    s_add_u32 s12, s84, 4194304
    s_addc_u32 s13, s85, 0
    s_and_b32 s13, s13, 0xffff
    s_mov_b32 s14, 7340032
    s_mov_b32 s15, 0x00020000
    s_mov_b32 s16, s76
    s_and_b32 s17, s77, 0xffff
    s_mov_b32 s18, 1835008
    s_mov_b32 s19, 0x00020000
    s_add_u32 s20, s84, 2097152
    s_addc_u32 s21, s85, 0
    s_and_b32 s21, s21, 0xffff
    s_mov_b32 s22, 2097152
    s_mov_b32 s23, 0x00020000
    s_mov_b32 s36, s80
    s_and_b32 s37, s81, 0xffff
    s_mov_b32 s38, 2097152
    s_mov_b32 s39, 0x00020000
    s_mov_b32 s60, s78
    s_and_b32 s61, s79, 0xffff
    s_mov_b32 s62, 1024
    s_mov_b32 s63, 0x00020000
    s_lshr_b32 s27, s26, 1
    s_and_b32 s28, s26, 1
    s_lshl_b32 s29, s24, 6
    v_lshrrev_b32 v5, 4, v1
    v_and_b32 v6, 15, v1
    s_lshl_b32 s3, s26, 2
    v_add_u32 v7, s3, v5
    v_xor_b32 v6, v6, v7
    s_mul_i32 s3, s26, 4
    s_add_u32 s3, s3, s29
    v_add_u32 v5, s3, v5
    s_mov_b32 s3, 3584
    v_mul_lo_u32 v5, v5, s3
    v_lshl_add_u32 v8, v6, 4, v5
    v_lshrrev_b32 v5, 3, v1
    v_bfe_u32 v6, v1, 1, 2
    v_bfe_u32 v7, v1, 4, 1
    s_lshl_b32 s3, s28, 1
    v_or_b32 v7, s3, v7
    v_xor_b32 v6, v6, v7
    v_and_b32 v7, 1, v1
    v_lshlrev_b32 v7, 4, v7
    v_lshl_add_u32 v7, v6, 5, v7
    s_lshl_b32 s3, s26, 3
    v_add_u32 v5, s3, v5
    v_lshl_add_u32 v7, v5, 10, v7
    s_lshl_b32 s3, s25, 7
    v_add_u32 v9, s3, v7
    s_mov_b32 s40, 0
    s_mov_b32 s41, 0
    s_mov_b32 s42, 0
    s_mov_b32 s43, 0
    s_mov_b32 s44, 0
    s_lshl_b32 s46, s26, 10
    s_cmp_eq_u32 s51, 0
    s_cbranch_scc1 L_k4_w2_kernel_compute
L_k4_w2_kernel_loader:
    s_add_u32 s47, s41, s46
    s_add_u32 m0, s47, 0
    s_add_u32 s48, s42, 0
    buffer_load_dwordx4 v8, s[12:15], s48 offen lds
    s_add_u32 m0, s47, 4096
    s_add_u32 s48, s42, 57344
    buffer_load_dwordx4 v8, s[12:15], s48 offen lds
    s_add_u32 m0, s47, 8192
    s_add_u32 s48, s42, 114688
    buffer_load_dwordx4 v8, s[12:15], s48 offen lds
    s_add_u32 m0, s47, 12288
    s_add_u32 s48, s42, 172032
    buffer_load_dwordx4 v8, s[12:15], s48 offen lds
    s_add_u32 m0, s47, 16384
    s_add_u32 s48, s43, 0
    buffer_load_dwordx4 v9, s[16:19], s48 offen lds
    s_add_u32 m0, s47, 20480
    s_add_u32 s48, s43, 32768
    buffer_load_dwordx4 v9, s[16:19], s48 offen lds
    s_add_u32 m0, s47, 24576
    s_add_u32 s48, s43, 65536
    buffer_load_dwordx4 v9, s[16:19], s48 offen lds
    s_add_u32 m0, s47, 28672
    s_add_u32 s48, s43, 98304
    buffer_load_dwordx4 v9, s[16:19], s48 offen lds
    s_add_u32 s41, s41, 32768
    s_cmp_ge_u32 s41, 98304
    s_cselect_b32 s41, 0, s41
    s_add_u32 s42, s42, 256
    s_add_u32 s43, s43, 131072
    s_cmp_ge_u32 s42, 3584
    s_cselect_b32 s42, 0, s42
    s_cselect_b32 s43, 0, s43
    s_add_u32 s47, s41, s46
    s_add_u32 m0, s47, 0
    s_add_u32 s48, s42, 0
    buffer_load_dwordx4 v8, s[12:15], s48 offen lds
    s_add_u32 m0, s47, 4096
    s_add_u32 s48, s42, 57344
    buffer_load_dwordx4 v8, s[12:15], s48 offen lds
    s_add_u32 m0, s47, 8192
    s_add_u32 s48, s42, 114688
    buffer_load_dwordx4 v8, s[12:15], s48 offen lds
    s_add_u32 m0, s47, 12288
    s_add_u32 s48, s42, 172032
    buffer_load_dwordx4 v8, s[12:15], s48 offen lds
    s_add_u32 m0, s47, 16384
    s_add_u32 s48, s43, 0
    buffer_load_dwordx4 v9, s[16:19], s48 offen lds
    s_add_u32 m0, s47, 20480
    s_add_u32 s48, s43, 32768
    buffer_load_dwordx4 v9, s[16:19], s48 offen lds
    s_add_u32 m0, s47, 24576
    s_add_u32 s48, s43, 65536
    buffer_load_dwordx4 v9, s[16:19], s48 offen lds
    s_add_u32 m0, s47, 28672
    s_add_u32 s48, s43, 98304
    buffer_load_dwordx4 v9, s[16:19], s48 offen lds
    s_add_u32 s41, s41, 32768
    s_cmp_ge_u32 s41, 98304
    s_cselect_b32 s41, 0, s41
    s_add_u32 s42, s42, 256
    s_add_u32 s43, s43, 131072
    s_cmp_ge_u32 s42, 3584
    s_cselect_b32 s42, 0, s42
    s_cselect_b32 s43, 0, s43
    s_waitcnt vmcnt(8)
    s_barrier
    s_add_u32 s47, s41, s46
    s_add_u32 m0, s47, 0
    s_add_u32 s48, s42, 0
    buffer_load_dwordx4 v8, s[12:15], s48 offen lds
    s_add_u32 m0, s47, 4096
    s_add_u32 s48, s42, 57344
    buffer_load_dwordx4 v8, s[12:15], s48 offen lds
    s_add_u32 m0, s47, 8192
    s_add_u32 s48, s42, 114688
    buffer_load_dwordx4 v8, s[12:15], s48 offen lds
    s_add_u32 m0, s47, 12288
    s_add_u32 s48, s42, 172032
    buffer_load_dwordx4 v8, s[12:15], s48 offen lds
    s_add_u32 m0, s47, 16384
    s_add_u32 s48, s43, 0
    buffer_load_dwordx4 v9, s[16:19], s48 offen lds
    s_add_u32 m0, s47, 20480
    s_add_u32 s48, s43, 32768
    buffer_load_dwordx4 v9, s[16:19], s48 offen lds
    s_add_u32 m0, s47, 24576
    s_add_u32 s48, s43, 65536
    buffer_load_dwordx4 v9, s[16:19], s48 offen lds
    s_add_u32 m0, s47, 28672
    s_add_u32 s48, s43, 98304
    buffer_load_dwordx4 v9, s[16:19], s48 offen lds
    s_add_u32 s41, s41, 32768
    s_cmp_ge_u32 s41, 98304
    s_cselect_b32 s41, 0, s41
    s_add_u32 s42, s42, 256
    s_add_u32 s43, s43, 131072
    s_cmp_ge_u32 s42, 3584
    s_cselect_b32 s42, 0, s42
    s_cselect_b32 s43, 0, s43
L_k4_w2_kernel_lloop:
    s_cmp_lt_u32 s40, 12
    s_cbranch_scc1 L_k4_w2_kernel_wfull
    s_cmp_eq_u32 s40, 12
    s_cbranch_scc0 L_k4_w2_kernel_w0
    s_waitcnt vmcnt(0)
    s_branch L_k4_w2_kernel_wdone
L_k4_w2_kernel_w0:
    s_waitcnt vmcnt(0)
    s_branch L_k4_w2_kernel_wdone
L_k4_w2_kernel_wfull:
    s_waitcnt vmcnt(8)
L_k4_w2_kernel_wdone:
    s_barrier
    s_cmp_lt_u32 s40, 11
    s_cbranch_scc0 L_k4_w2_kernel_noissue
    s_add_u32 s47, s41, s46
    s_add_u32 m0, s47, 0
    s_add_u32 s48, s42, 0
    buffer_load_dwordx4 v8, s[12:15], s48 offen lds
    s_add_u32 m0, s47, 4096
    s_add_u32 s48, s42, 57344
    buffer_load_dwordx4 v8, s[12:15], s48 offen lds
    s_add_u32 m0, s47, 8192
    s_add_u32 s48, s42, 114688
    buffer_load_dwordx4 v8, s[12:15], s48 offen lds
    s_add_u32 m0, s47, 12288
    s_add_u32 s48, s42, 172032
    buffer_load_dwordx4 v8, s[12:15], s48 offen lds
    s_add_u32 m0, s47, 16384
    s_add_u32 s48, s43, 0
    buffer_load_dwordx4 v9, s[16:19], s48 offen lds
    s_add_u32 m0, s47, 20480
    s_add_u32 s48, s43, 32768
    buffer_load_dwordx4 v9, s[16:19], s48 offen lds
    s_add_u32 m0, s47, 24576
    s_add_u32 s48, s43, 65536
    buffer_load_dwordx4 v9, s[16:19], s48 offen lds
    s_add_u32 m0, s47, 28672
    s_add_u32 s48, s43, 98304
    buffer_load_dwordx4 v9, s[16:19], s48 offen lds
    s_add_u32 s41, s41, 32768
    s_cmp_ge_u32 s41, 98304
    s_cselect_b32 s41, 0, s41
    s_add_u32 s42, s42, 256
    s_add_u32 s43, s43, 131072
    s_cmp_ge_u32 s42, 3584
    s_cselect_b32 s42, 0, s42
    s_cselect_b32 s43, 0, s43
L_k4_w2_kernel_noissue:
    s_add_u32 s40, s40, 1
    s_cmp_lt_u32 s40, 14
    s_cbranch_scc1 L_k4_w2_kernel_lloop
    s_barrier
    s_barrier
    s_endpgm
L_k4_w2_kernel_compute:
    s_lshl_b32 s30, s26, 4
    s_add_u32 s30, s30, s29
    v_lshrrev_b32 v5, 3, v1
    v_add_u32 v5, s30, v5
    v_and_b32 v6, 7, v1
    v_lshlrev_b32 v6, 4, v6
    s_lshl_b32 s30, s25, 7
    v_add_u32 v12, s30, v6
    v_lshl_add_u32 v10, v5, 10, v12
    v_add_u32 v11, 0x2000, v10
    buffer_load_dwordx4 v[96:99], v10, s[20:23], 0 offen
    buffer_load_dwordx4 v[100:103], v11, s[20:23], 0 offen
    buffer_load_dwordx4 v[104:107], v12, s[60:63], 0 offen
    v_mov_b32 v5, v2
    v_mul_u32_u24 v6, 256, v2
    v_add_u32 v7, 0, v3
    v_xor_b32 v7, v7, v5
    v_lshl_add_u32 v13, v7, 4, v6
    v_add_u32 v7, 4, v3
    v_xor_b32 v7, v7, v5
    v_lshl_add_u32 v14, v7, 4, v6
    v_add_u32 v7, 8, v3
    v_xor_b32 v7, v7, v5
    v_lshl_add_u32 v15, v7, 4, v6
    v_add_u32 v7, 12, v3
    v_xor_b32 v7, v7, v5
    v_lshl_add_u32 v16, v7, 4, v6
    s_mul_i32 s3, s27, 8192
    v_add_u32 v13, s3, v13
    v_add_u32 v14, s3, v14
    v_add_u32 v15, s3, v15
    v_add_u32 v16, s3, v16
    v_lshrrev_b32 v5, 2, v2
    v_and_b32 v6, 3, v2
    v_lshl_add_u32 v7, v3, 3, v5
    v_lshlrev_b32 v7, 7, v7
    v_lshl_add_u32 v7, v6, 3, v7
    v_add_u32 v7, 16384, v7
    v_lshrrev_b32 v5, 1, v5
    v_and_b32 v6, 1, v3
    v_lshl_add_u32 v5, v6, 1, v5
    s_lshl_b32 s3, s28, 1
    v_xor_b32 v6, s3, v5
    v_lshl_add_u32 v17, v6, 5, v7
    v_xor_b32 v6, 1, v6
    v_lshl_add_u32 v18, v6, 5, v7
    v_mov_b32 v32, 0
    v_mov_b32 v33, 0
    v_mov_b32 v34, 0
    v_mov_b32 v35, 0
    v_mov_b32 v36, 0
    v_mov_b32 v37, 0
    v_mov_b32 v38, 0
    v_mov_b32 v39, 0
    v_mov_b32 v40, 0
    v_mov_b32 v41, 0
    v_mov_b32 v42, 0
    v_mov_b32 v43, 0
    v_mov_b32 v44, 0
    v_mov_b32 v45, 0
    v_mov_b32 v46, 0
    v_mov_b32 v47, 0
    v_mov_b32 v20, v13
    v_mov_b32 v21, v14
    v_mov_b32 v22, v15
    v_mov_b32 v23, v16
    v_mov_b32 v24, v17
    v_mov_b32 v25, v18
    s_barrier
    ds_read_b128 v[64:67], v20 offset:0
    ds_read_b128 v[68:71], v20 offset:4096
    ds_read_b64_tr_b16 v[48:49], v24 offset:0
    ds_read_b64_tr_b16 v[50:51], v24 offset:512
    ds_read_b64_tr_b16 v[52:53], v25 offset:0
    ds_read_b64_tr_b16 v[54:55], v25 offset:512
    s_waitcnt lgkmcnt(0)
L_k4_w2_kernel_loop:
    v_mfma_f32_16x16x32_bf16 v[32:35], v[48:51], v[64:67], v[32:35]
    ds_read_b128 v[72:75], v21 offset:0
    ds_read_b128 v[76:79], v21 offset:4096
    v_mfma_f32_16x16x32_bf16 v[36:39], v[52:55], v[64:67], v[36:39]
    ds_read_b64_tr_b16 v[56:57], v24 offset:4096
    v_mfma_f32_16x16x32_bf16 v[40:43], v[48:51], v[68:71], v[40:43]
    ds_read_b64_tr_b16 v[58:59], v24 offset:4608
    ds_read_b64_tr_b16 v[60:61], v25 offset:4096
    v_mfma_f32_16x16x32_bf16 v[44:47], v[52:55], v[68:71], v[44:47]
    ds_read_b64_tr_b16 v[62:63], v25 offset:4608
    s_waitcnt lgkmcnt(0)
    v_mfma_f32_16x16x32_bf16 v[32:35], v[56:59], v[72:75], v[32:35]
    ds_read_b128 v[64:67], v22 offset:0
    ds_read_b128 v[68:71], v22 offset:4096
    v_mfma_f32_16x16x32_bf16 v[36:39], v[60:63], v[72:75], v[36:39]
    ds_read_b64_tr_b16 v[48:49], v24 offset:8192
    v_mfma_f32_16x16x32_bf16 v[40:43], v[56:59], v[76:79], v[40:43]
    ds_read_b64_tr_b16 v[50:51], v24 offset:8704
    ds_read_b64_tr_b16 v[52:53], v25 offset:8192
    v_mfma_f32_16x16x32_bf16 v[44:47], v[60:63], v[76:79], v[44:47]
    ds_read_b64_tr_b16 v[54:55], v25 offset:8704
    s_waitcnt lgkmcnt(0)
    v_mfma_f32_16x16x32_bf16 v[32:35], v[48:51], v[64:67], v[32:35]
    ds_read_b128 v[72:75], v23 offset:0
    ds_read_b128 v[76:79], v23 offset:4096
    v_mfma_f32_16x16x32_bf16 v[36:39], v[52:55], v[64:67], v[36:39]
    ds_read_b64_tr_b16 v[56:57], v24 offset:12288
    v_mfma_f32_16x16x32_bf16 v[40:43], v[48:51], v[68:71], v[40:43]
    ds_read_b64_tr_b16 v[58:59], v24 offset:12800
    ds_read_b64_tr_b16 v[60:61], v25 offset:12288
    v_mfma_f32_16x16x32_bf16 v[44:47], v[52:55], v[68:71], v[44:47]
    ds_read_b64_tr_b16 v[62:63], v25 offset:12800
    s_waitcnt lgkmcnt(0)
    s_barrier
    s_add_u32 s44, s44, 32768
    s_cmp_ge_u32 s44, 98304
    s_cselect_b32 s44, 0, s44
    v_add_u32 v20, s44, v13
    v_add_u32 v21, s44, v14
    v_add_u32 v22, s44, v15
    v_add_u32 v23, s44, v16
    v_add_u32 v24, s44, v17
    v_add_u32 v25, s44, v18
    v_mfma_f32_16x16x32_bf16 v[32:35], v[56:59], v[72:75], v[32:35]
    ds_read_b128 v[64:67], v20 offset:0
    ds_read_b128 v[68:71], v20 offset:4096
    v_mfma_f32_16x16x32_bf16 v[36:39], v[60:63], v[72:75], v[36:39]
    ds_read_b64_tr_b16 v[48:49], v24 offset:0
    v_mfma_f32_16x16x32_bf16 v[40:43], v[56:59], v[76:79], v[40:43]
    ds_read_b64_tr_b16 v[50:51], v24 offset:512
    ds_read_b64_tr_b16 v[52:53], v25 offset:0
    v_mfma_f32_16x16x32_bf16 v[44:47], v[60:63], v[76:79], v[44:47]
    ds_read_b64_tr_b16 v[54:55], v25 offset:512
    s_waitcnt lgkmcnt(0)
    s_add_u32 s40, s40, 1
    s_cmp_lt_u32 s40, 14
    s_cbranch_scc1 L_k4_w2_kernel_loop
    s_nop 7
    s_nop 7
    s_waitcnt vmcnt(0)
    s_lshl_b32 s3, s27, 5
    v_add_u32 v4, s3, v2
    v_mul_u32_u24 v4, 272, v4
    v_lshl_add_u32 v4, v3, 4, v4
    s_lshl_b32 s3, s28, 7
    v_add_u32 v4, s3, v4
    s_barrier
    ds_write_b128 v4, v[32:35] offset:0
    ds_write_b128 v4, v[36:39] offset:64
    ds_write_b128 v4, v[40:43] offset:4352
    ds_write_b128 v4, v[44:47] offset:4416
    v_lshrrev_b32 v5, 3, v1
    s_lshl_b32 s3, s26, 4
    v_add_u32 v5, s3, v5
    v_mul_u32_u24 v5, 272, v5
    v_and_b32 v6, 7, v1
    v_lshl_add_u32 v5, v6, 5, v5
    s_waitcnt lgkmcnt(0)
    s_barrier
    ds_read_b128 v[48:51], v5 offset:0
    ds_read_b128 v[52:55], v5 offset:16
    ds_read_b128 v[56:59], v5 offset:2176
    ds_read_b128 v[60:63], v5 offset:2192
    v_lshlrev_b32 v72, 16, v104
    v_and_b32 v73, 0xffff0000, v104
    v_lshlrev_b32 v74, 16, v105
    v_and_b32 v75, 0xffff0000, v105
    v_lshlrev_b32 v76, 16, v106
    v_and_b32 v77, 0xffff0000, v106
    v_lshlrev_b32 v78, 16, v107
    v_and_b32 v79, 0xffff0000, v107
    s_waitcnt lgkmcnt(0)
    v_lshlrev_b32 v64, 16, v96
    v_and_b32 v65, 0xffff0000, v96
    v_lshlrev_b32 v66, 16, v97
    v_and_b32 v67, 0xffff0000, v97
    v_lshlrev_b32 v68, 16, v98
    v_and_b32 v69, 0xffff0000, v98
    v_lshlrev_b32 v70, 16, v99
    v_and_b32 v71, 0xffff0000, v99
    v_pk_add_f32 v[48:49], v[48:49], v[64:65]
    v_pk_add_f32 v[50:51], v[50:51], v[66:67]
    v_pk_add_f32 v[52:53], v[52:53], v[68:69]
    v_pk_add_f32 v[54:55], v[54:55], v[70:71]
    v_pk_add_f32 v[48:49], v[48:49], v[72:73]
    v_pk_add_f32 v[50:51], v[50:51], v[74:75]
    v_pk_add_f32 v[52:53], v[52:53], v[76:77]
    v_pk_add_f32 v[54:55], v[54:55], v[78:79]
    v_cvt_pk_bf16_f32 v96, v48, v49
    v_cvt_pk_bf16_f32 v97, v50, v51
    v_cvt_pk_bf16_f32 v98, v52, v53
    v_cvt_pk_bf16_f32 v99, v54, v55
    buffer_store_dwordx4 v[96:99], v10, s[36:39], 0 offen
    v_lshlrev_b32 v64, 16, v100
    v_and_b32 v65, 0xffff0000, v100
    v_lshlrev_b32 v66, 16, v101
    v_and_b32 v67, 0xffff0000, v101
    v_lshlrev_b32 v68, 16, v102
    v_and_b32 v69, 0xffff0000, v102
    v_lshlrev_b32 v70, 16, v103
    v_and_b32 v71, 0xffff0000, v103
    v_pk_add_f32 v[56:57], v[56:57], v[64:65]
    v_pk_add_f32 v[58:59], v[58:59], v[66:67]
    v_pk_add_f32 v[60:61], v[60:61], v[68:69]
    v_pk_add_f32 v[62:63], v[62:63], v[70:71]
    v_pk_add_f32 v[56:57], v[56:57], v[72:73]
    v_pk_add_f32 v[58:59], v[58:59], v[74:75]
    v_pk_add_f32 v[60:61], v[60:61], v[76:77]
    v_pk_add_f32 v[62:63], v[62:63], v[78:79]
    v_cvt_pk_bf16_f32 v100, v56, v57
    v_cvt_pk_bf16_f32 v101, v58, v59
    v_cvt_pk_bf16_f32 v102, v60, v61
    v_cvt_pk_bf16_f32 v103, v62, v63
    buffer_store_dwordx4 v[100:103], v11, s[36:39], 0 offen
L_k4_w2_kernel_done:
    s_endpgm
L_code_end:
.section .rodata,"a"
.p2align 6
.amdhsa_kernel k1_qkv_attn_kernel
  .amdhsa_next_free_vgpr 240
  .amdhsa_next_free_sgpr 102
  .amdhsa_accum_offset 240
  .amdhsa_group_segment_fixed_size 0
  .amdhsa_kernarg_size 88
  .amdhsa_user_sgpr_count 2
  .amdhsa_user_sgpr_kernarg_segment_ptr 1
  .amdhsa_system_sgpr_workgroup_id_x 1
.end_amdhsa_kernel
.p2align 6
.amdhsa_kernel k2_wo_kernel
  .amdhsa_next_free_vgpr 112
  .amdhsa_next_free_sgpr 102
  .amdhsa_accum_offset 112
  .amdhsa_group_segment_fixed_size 0
  .amdhsa_kernarg_size 88
  .amdhsa_user_sgpr_count 2
  .amdhsa_user_sgpr_kernarg_segment_ptr 1
  .amdhsa_system_sgpr_workgroup_id_x 1
.end_amdhsa_kernel
.p2align 6
.amdhsa_kernel k3_w1_kernel
  .amdhsa_next_free_vgpr 244
  .amdhsa_next_free_sgpr 102
  .amdhsa_accum_offset 244
  .amdhsa_group_segment_fixed_size 0
  .amdhsa_kernarg_size 88
  .amdhsa_user_sgpr_count 2
  .amdhsa_user_sgpr_kernarg_segment_ptr 1
  .amdhsa_system_sgpr_workgroup_id_x 1
.end_amdhsa_kernel
.p2align 6
.amdhsa_kernel k4_w2_kernel
  .amdhsa_next_free_vgpr 112
  .amdhsa_next_free_sgpr 102
  .amdhsa_accum_offset 112
  .amdhsa_group_segment_fixed_size 0
  .amdhsa_kernarg_size 88
  .amdhsa_user_sgpr_count 2
  .amdhsa_user_sgpr_kernarg_segment_ptr 1
  .amdhsa_system_sgpr_workgroup_id_x 1
.end_amdhsa_kernel
```
